```python
import torch

def _softmax(x, axis=-1):
    return torch.softmax(x, dim=axis)
def _gelu(x):
    return torch.nn.functional.gelu(x, approximate="tanh")
def _silu(x):
    return torch.nn.functional.silu(x)
def _sigmoid(x):
    return torch.sigmoid(x)
def _layernorm(x, axis=-1, eps=1e-5):
    m = x.mean(dim=axis, keepdim=True)
    v = x.var(dim=axis, keepdim=True, unbiased=False)
    return (x - m) / torch.sqrt(v + eps)
def _scatter_add(tgt, idx, src, axis=0):
    return tgt.clone().index_add_(axis, idx, src)
def _segment_sum(src, seg, n):
    out = torch.zeros((n,) + src.shape[1:], dtype=src.dtype)
    return out.index_add_(0, seg, src)
def _pad(x, pw):
    flat = tuple(v for pair in reversed(pw) for v in pair)
    return torch.nn.functional.pad(x, flat)

kernel_name = 'gated_mix__sliding_local_dilated__spectral_fnet__prompt'

def setup_inputs():

    _w = (lambda a: (lambda t: t.to(torch.bfloat16) if t.is_floating_point() else t)(torch.as_tensor(a)))
    def _A_setup():
        B, S, D = 1, 2048, 1024
        return {
            "x": _w((lambda *s: torch.randn(*s, dtype=torch.bfloat16) * 0.05)(B, S, D)),
            "wqkv": _w((lambda *s: torch.randn(*s, dtype=torch.bfloat16) * 1.6)(D, 3 * D)),
            "wo": _w((lambda *s: torch.randn(*s, dtype=torch.bfloat16) * 0.2)(D, D)),
        }
    _A_in = _A_setup()

    def _B_setup():
        B, S, D = 1, 2048, 1024
        ns = torch.arange(S)[:, None] * torch.arange(S)[None, :]
        nd = torch.arange(D)[:, None] * torch.arange(D)[None, :]
        Ws_re = torch.cos(-2.0 * torch.pi * ns / S).to(float)
        Ws_im = torch.sin(-2.0 * torch.pi * ns / S).to(float)
        Wd_re = torch.cos(-2.0 * torch.pi * nd / D).to(float)
        Wd_im = torch.sin(-2.0 * torch.pi * nd / D).to(float)
        return {
            "x": _w((lambda *s: torch.randn(*s, dtype=torch.bfloat16) * 0.05)(B, S, D)),
            "dft_seq_re": _w(Ws_re),
            "dft_seq_im": _w(Ws_im),
            "dft_hid_re": _w(Wd_re),
            "dft_hid_im": _w(Wd_im),
        }
    _B_in = _B_setup()

    return {
        "A_x": _A_in["x"],
        "A_wqkv": _A_in["wqkv"],
        "A_wo": _A_in["wo"],
        "B_x": _B_in["x"],
        "B_dft_seq_re": _B_in["dft_seq_re"],
        "B_dft_seq_im": _B_in["dft_seq_im"],
        "B_dft_hid_re": _B_in["dft_hid_re"],
        "B_dft_hid_im": _B_in["dft_hid_im"],
        "gate_w": _w((lambda *s: torch.randn(*s, dtype=torch.bfloat16) * 0.05)(1024) * 16.0),
    }

def reference(A_x, A_wqkv, A_wo, B_x, B_dft_seq_re, B_dft_seq_im, B_dft_hid_re, B_dft_hid_im, gate_w):
    def _A_ref(x, wqkv, wo):
        B, S, D = x.shape
        H = 32; Dh = D // H
        W, dil = 8, 2
        qkv = (lambda x, *d: x.permute(*d))((x @ wqkv).reshape(B, S, 3, H, Dh), 2, 0, 3, 1, 4)
        q, k, v = qkv[0], qkv[1], qkv[2]
        scale = Dh ** -0.5
        pos = torch.arange(S)
        off = torch.arange(W) * dil
        idx = pos[:, None] - off[None, :]
        mask = idx >= 0
        idx_c = torch.where(mask, idx, 0).reshape(-1)
        kg = k[:, :, idx_c, :].reshape(B, H, S, W, Dh)
        vg = v[:, :, idx_c, :].reshape(B, H, S, W, Dh)
        logits = torch.einsum("bhsd,bhswd->bhsw", q, kg) * scale
        logits = torch.where(mask[None, None, :, :], logits, -1e9)
        attn = _softmax(logits, axis=-1)
        o = torch.einsum("bhsw,bhswd->bhsd", attn, vg)
        return (lambda x, *d: x.permute(*d))(o, 0, 2, 1, 3).reshape(B, S, D) @ wo

    def _B_ref(x, dft_seq_re, dft_seq_im, dft_hid_re, dft_hid_im):
        a = torch.einsum("bsd,ed->bse", x, dft_hid_re)
        b = torch.einsum("bsd,ed->bse", x, dft_hid_im)
        y = torch.einsum("ts,bse->bte", dft_seq_re, a) - torch.einsum("ts,bse->bte", dft_seq_im, b)
        return y

    x = A_x
    g = _sigmoid((x * gate_w).sum(-1, keepdims=True))
    a = _A_ref(x, A_wqkv, A_wo)
    b = _B_ref(x, B_dft_seq_re, B_dft_seq_im, B_dft_hid_re, B_dft_hid_im)
    return g * a + (1 - g) * b
```

```asm
; @launch kernel=k1_kernel grid=(256,1,1) block=(512,1,1) lds=163840
; @launch kernel=k2_kernel grid=(256,1,1) block=(512,1,1) lds=163840
.amdgcn_target "amdgcn-amd-amdhsa--gfx950"
.text
.globl k1_kernel
.p2align 8
.type k1_kernel,@function
k1_kernel:
    s_cmp_ge_u32 s2, 256
    s_cbranch_scc1 K1_END
    s_load_dwordx4 s[4:7], s[0:1], 0
    s_load_dwordx2 s[8:9], s[0:1], 64
    s_load_dwordx2 s[10:11], s[0:1], 88
    s_load_dwordx2 s[56:57], s[0:1], 16
    s_load_dwordx2 s[92:93], s[0:1], 72
    v_lshrrev_b32 v1, 6, v0
    v_and_b32 v0, 63, v0
    v_readfirstlane_b32 s28, v1
    s_and_b32 s33, s2, 7
    s_lshr_b32 s34, s2, 3
    s_and_b32 s35, s33, 1
    s_and_b32 s36, s34, 7
    s_lshl3_add_u32 s29, s35, s36
    s_and_b32 s37, s33, 2
    s_lshr_b32 s38, s33, 2
    s_or_b32 s37, s37, s38
    s_lshr_b32 s38, s34, 3
    s_lshl2_add_u32 s30, s37, s38
    s_getpc_b64 s[90:91]
K1_PC:
    s_lshl3_add_u32 s39, s34, s28
    s_lshl_b32 s39, s39, 7
    s_min_u32 s39, s39, CODE_END-K1_PC-4
    s_add_u32 s88, s90, s39
    s_addc_u32 s89, s91, 0
    v_mov_b32 v2, s88
    v_mov_b32 v3, s89
    global_load_dword v1, v[2:3], off
    s_cmp_lt_u32 s28, 4
    s_cbranch_scc1 K1_COMP
    s_sub_u32 s51, s28, 4
    v_lshrrev_b32 v16, 3, v0
    v_and_b32 v17, 7, v0
    s_and_b32 s39, s51, 1
    s_lshl_b32 s39, s39, 2
    v_and_or_b32 v18, v16, 2, s39
    v_xor_b32 v18, v18, v17
    v_lshlrev_b32 v18, 4, v18
    s_lshl_b32 s40, s51, 3
    v_add_u32 v19, s40, v16
    v_mul_u32_u24 v19, 6144, v19
    s_lshl_b32 s40, s30, 7
    v_add3_u32 v7, v19, v18, s40
    s_add_u32 s40, s38, s36
    s_and_b32 s40, s40, 3
    s_lshl_b32 s50, s40, 2
    s_lshr_b32 s40, s36, 2
    s_lshl_b32 s40, s40, 1
    s_and_b32 s41, s30, 7
    s_cmp_eq_u32 s41, 3
    s_cselect_b32 s40, s40, 0
    s_add_u32 s50, s50, s40
    s_lshl_b32 s40, s51, 10
    s_waitcnt lgkmcnt(0)
    s_mov_b32 s16, s6
    s_and_b32 s17, s7, 0xffff
    s_mov_b32 s18, 0x600000
    s_mov_b32 s19, 0x00020000
    s_add_u32 s52, s50, 0
    s_and_b32 s52, s52, 15
    s_mul_i32 s53, s52, 393216
    s_lshl_b32 s44, s52, 7
    s_add_u32 m0, s40, 18432
    s_nop 0
    buffer_load_dwordx4 v7, s[16:19], s53 offen lds
    v_lshrrev_b32 v18, 1, v16
    v_or_b32 v18, s39, v18
    v_xor_b32 v18, v18, v17
    v_lshlrev_b32 v18, 4, v18
    v_lshl_add_u32 v18, v16, 12, v18
    s_lshl_b32 s46, s29, 7
    s_add_u32 m0, s40, 26624
    s_add_u32 s45, s53, 2048
    buffer_load_dwordx4 v7, s[16:19], s45 offen lds
    s_lshl4_add_u32 s46, s51, s46
    s_add_i32 s47, s46, -16
    s_lshl_b32 s47, s47, 11
    v_add_u32 v2, s47, v18
    s_add_i32 s47, s46, 48
    s_add_u32 m0, s40, 34816
    s_add_u32 s45, s53, 4096
    buffer_load_dwordx4 v7, s[16:19], s45 offen lds
    s_lshl_b32 s47, s47, 11
    v_add_u32 v3, s47, v18
    s_cmp_ge_u32 s51, 1
    s_cselect_b32 s47, 143, 0
    s_sub_i32 s47, s46, s47
    s_add_i32 s47, s47, 112
    s_add_u32 m0, s40, 22528
    s_add_u32 s45, s53, 196608
    buffer_load_dwordx4 v7, s[16:19], s45 offen lds
    s_lshl_b32 s47, s47, 11
    v_add_u32 v4, s47, v18
    s_add_i32 s47, s46, 33
    s_lshl_b32 s47, s47, 11
    v_add_u32 v5, s47, v18
    s_add_i32 s47, s46, 97
    s_add_u32 m0, s40, 30720
    s_add_u32 s45, s53, 198656
    buffer_load_dwordx4 v7, s[16:19], s45 offen lds
    s_lshl_b32 s47, s47, 11
    v_add_u32 v6, s47, v18
    s_add_u32 s41, s40, 16384
    s_add_u32 s42, s40, 59392
    s_add_u32 s43, s40, 102400
    s_add_u32 m0, s40, 38912
    s_add_u32 s45, s53, 200704
    buffer_load_dwordx4 v7, s[16:19], s45 offen lds
    s_cmp_ge_u32 s51, 2
    s_cselect_b32 s41, 162048, s41
    s_cselect_b32 s42, 162048, s42
    s_cselect_b32 s43, 162048, s43
    s_mov_b32 s12, s4
    s_and_b32 s13, s5, 0xffff
    s_mov_b32 s14, 0x400000
    s_mov_b32 s15, 0x00020000
    s_add_u32 m0, s40, 0
    s_nop 0
    buffer_load_dwordx4 v2, s[12:15], s44 offen lds
    s_add_u32 m0, s40, 4096
    s_nop 0
    buffer_load_dwordx4 v3, s[12:15], s44 offen lds
    s_add_u32 m0, s40, 8192
    s_nop 0
    buffer_load_dwordx4 v4, s[12:15], s44 offen lds
    s_add_u32 m0, s40, 12288
    s_nop 0
    buffer_load_dwordx4 v5, s[12:15], s44 offen lds
    s_cmp_eq_u32 s51, 3
    s_cselect_b32 s64, s16, s12
    s_cselect_b32 s65, s17, s13
    s_cselect_b32 s66, s18, s14
    s_mov_b32 s67, 0x00020000
    s_cselect_b32 s62, 393216, 64
    s_cselect_b32 s55, 0, 64
    s_add_u32 s62, s62, s55
    s_cmp_ge_u32 s51, 2
    s_cselect_b32 s63, 0, 0
    s_cbranch_scc0 S5_DONE
    v_mov_b32 v19, 0x80000000
    v_mov_b32 v6, v19
S5_DONE:
    s_add_u32 s45, s52, s63
    s_mul_i32 s45, s45, s62
    s_mov_b32 m0, s41
    s_nop 0
    buffer_load_dwordx4 v6, s[64:67], s45 offen lds
    s_add_u32 s52, s50, 1
    s_and_b32 s52, s52, 15
    s_mul_i32 s53, s52, 393216
    s_lshl_b32 s44, s52, 7
    s_add_u32 m0, s40, 61440
    s_nop 0
    buffer_load_dwordx4 v7, s[16:19], s53 offen lds
    s_lshl2_add_u32 s46, s51, 163216
    v_mov_b32 v255, s46
    v_mov_b32 v18, 0
    ds_write_b32 v255, v18
    s_mov_b32 s20, s10
    s_and_b32 s21, s11, 0xffff
    s_mov_b32 s22, 0xe00000
    s_mov_b32 s23, 0x00020000
    s_mov_b32 s24, s8
    s_and_b32 s25, s9, 0xffff
    s_mov_b32 s26, 0x800
    s_mov_b32 s27, 0x00020000
    s_lshr_b32 s46, s34, 2
    s_lshl3_add_u32 s31, s33, s46
    s_and_b32 s32, s34, 3
    v_and_b32 v16, 15, v0
    v_lshrrev_b32 v17, 4, v0
    v_lshlrev_b32 v27, 4, v0
    s_add_u32 s45, s52, s63
    s_mul_i32 s45, s45, s62
    s_mov_b32 m0, s42
    s_nop 0
    buffer_load_dwordx4 v6, s[64:67], s45 offen lds
    v_bfe_u32 v18, v0, 2, 1
    v_bfe_u32 v19, v0, 3, 2
    v_and_b32 v20, 3, v0
    v_lshl_add_u32 v20, v19, 2, v20
    v_lshl_add_u32 v20, v18, 4, v20
    v_lshrrev_b32 v21, 5, v0
    v_cvt_f32_u32 v24, v20
    v_cvt_f32_u32 v25, v21
    v_mul_f32 v25, v25, v24
    s_mul_i32 s46, s51, 4128
    s_add_u32 s46, s46, 129024
    v_bfe_u32 v22, v20, 1, 1
    v_xor_b32 v23, v18, v21
    v_lshl_or_b32 v22, v23, 1, v22
    v_lshlrev_b32 v22, 4, v22
    v_lshl_add_u32 v22, v20, 6, v22
    v_add_u32 v12, s46, v22
    s_add_u32 m0, s40, 69632
    s_add_u32 s45, s53, 2048
    buffer_load_dwordx4 v7, s[16:19], s45 offen lds
    v_xor_b32 v22, 16, v22
    v_add_u32 v13, s46, v22
    v_bfe_u32 v22, v0, 3, 1
    v_lshlrev_b32 v22, 4, v22
    v_xor_b32 v22, v22, v27
    v_add_u32 v14, s46, v22
    v_xor_b32 v22, 32, v22
    v_add_u32 v15, s46, v22
    v_bfe_u32 v22, v0, 2, 2
    v_lshl_add_u32 v22, v21, 2, v22
    v_lshlrev_b32 v22, 6, v22
    v_bfe_u32 v23, v0, 4, 1
    v_lshl_add_u32 v22, v23, 5, v22
    v_and_b32 v23, 3, v0
    v_lshl_add_u32 v22, v23, 3, v22
    v_add_u32 v11, s46, v22
    v_mul_u32_u24 v22, 2064, v16
    s_add_u32 m0, s40, 77824
    s_add_u32 s45, s53, 4096
    buffer_load_dwordx4 v7, s[16:19], s45 offen lds
    v_lshl_add_u32 v22, v17, 6, v22
    s_lshl_b32 s46, s51, 9
    s_add_u32 s46, s46, 129024
    v_add_u32 v10, s46, v22
    v_mul_f32 v26, 0x3e000000, v25
    v_fmamk_f32 v18, v24, 0x00000000, v26
    v_fmamk_f32 v19, v24, 0x3d000000, v26
    v_cos_f32 v20, v18
    v_cos_f32 v21, v19
    v_sin_f32 v22, v18
    v_sin_f32 v23, v19
    v_cvt_pk_bf16_f32 v212, v20, v21
    v_cvt_pk_bf16_f32 v228, v22, v23
    v_cvt_pk_bf16_f32 v220, -v22, -v23
    v_fmamk_f32 v18, v24, 0x3d800000, v26
    v_fmamk_f32 v19, v24, 0x3dc00000, v26
    v_cos_f32 v20, v18
    s_add_u32 m0, s40, 65536
    s_add_u32 s45, s53, 196608
    buffer_load_dwordx4 v7, s[16:19], s45 offen lds
    v_cos_f32 v21, v19
    v_sin_f32 v22, v18
    v_sin_f32 v23, v19
    v_cvt_pk_bf16_f32 v213, v20, v21
    v_cvt_pk_bf16_f32 v229, v22, v23
    v_cvt_pk_bf16_f32 v221, -v22, -v23
    v_fmamk_f32 v18, v24, 0x3e800000, v26
    v_fmamk_f32 v19, v24, 0x3e900000, v26
    v_cos_f32 v20, v18
    v_cos_f32 v21, v19
    v_sin_f32 v22, v18
    v_sin_f32 v23, v19
    v_cvt_pk_bf16_f32 v214, v20, v21
    v_cvt_pk_bf16_f32 v230, v22, v23
    v_cvt_pk_bf16_f32 v222, -v22, -v23
    v_fmamk_f32 v18, v24, 0x3ea00000, v26
    v_fmamk_f32 v19, v24, 0x3eb00000, v26
    s_add_u32 m0, s40, 73728
    s_add_u32 s45, s53, 198656
    buffer_load_dwordx4 v7, s[16:19], s45 offen lds
    v_cos_f32 v20, v18
    v_cos_f32 v21, v19
    v_sin_f32 v22, v18
    v_sin_f32 v23, v19
    v_cvt_pk_bf16_f32 v215, v20, v21
    v_cvt_pk_bf16_f32 v231, v22, v23
    v_cvt_pk_bf16_f32 v223, -v22, -v23
    v_fmamk_f32 v18, v24, 0x3f000000, v26
    v_fmamk_f32 v19, v24, 0x3f080000, v26
    v_cos_f32 v20, v18
    v_cos_f32 v21, v19
    v_sin_f32 v22, v18
    v_sin_f32 v23, v19
    v_cvt_pk_bf16_f32 v216, v20, v21
    v_cvt_pk_bf16_f32 v232, v22, v23
    v_cvt_pk_bf16_f32 v224, -v22, -v23
    v_fmamk_f32 v18, v24, 0x3f100000, v26
    s_add_u32 m0, s40, 81920
    s_add_u32 s45, s53, 200704
    buffer_load_dwordx4 v7, s[16:19], s45 offen lds
    v_fmamk_f32 v19, v24, 0x3f180000, v26
    v_cos_f32 v20, v18
    v_cos_f32 v21, v19
    v_sin_f32 v22, v18
    v_sin_f32 v23, v19
    v_cvt_pk_bf16_f32 v217, v20, v21
    v_cvt_pk_bf16_f32 v233, v22, v23
    v_cvt_pk_bf16_f32 v225, -v22, -v23
    v_fmamk_f32 v18, v24, 0x3f400000, v26
    v_fmamk_f32 v19, v24, 0x3f480000, v26
    v_cos_f32 v20, v18
    v_cos_f32 v21, v19
    v_sin_f32 v22, v18
    v_sin_f32 v23, v19
    v_cvt_pk_bf16_f32 v218, v20, v21
    v_cvt_pk_bf16_f32 v234, v22, v23
    v_cvt_pk_bf16_f32 v226, -v22, -v23
    s_add_u32 m0, s40, 43008
    s_nop 0
    buffer_load_dwordx4 v2, s[12:15], s44 offen lds
    v_fmamk_f32 v18, v24, 0x3f500000, v26
    v_fmamk_f32 v19, v24, 0x3f580000, v26
    v_cos_f32 v20, v18
    v_cos_f32 v21, v19
    v_sin_f32 v22, v18
    v_sin_f32 v23, v19
    v_cvt_pk_bf16_f32 v219, v20, v21
    v_cvt_pk_bf16_f32 v235, v22, v23
    v_cvt_pk_bf16_f32 v227, -v22, -v23
    s_mov_b32 s48, 0x05040100
    s_mov_b32 s49, 0x07060302
    v_mul_f32 v26, 0x3b800000, v25
    v_fmamk_f32 v236, v24, 0x00000000, v26
    v_cos_f32 v188, v236
    v_sin_f32 v236, v236
    v_fmamk_f32 v237, v24, 0x3a800000, v26
    v_cos_f32 v189, v237
    s_add_u32 m0, s40, 47104
    s_nop 0
    buffer_load_dwordx4 v3, s[12:15], s44 offen lds
    v_sin_f32 v237, v237
    v_fmamk_f32 v238, v24, 0x3b000000, v26
    v_cos_f32 v190, v238
    v_sin_f32 v238, v238
    v_fmamk_f32 v239, v24, 0x3b400000, v26
    v_cos_f32 v191, v239
    v_sin_f32 v239, v239
    v_fmamk_f32 v240, v24, 0x3c000000, v26
    v_cos_f32 v192, v240
    v_sin_f32 v240, v240
    v_fmamk_f32 v241, v24, 0x3c100000, v26
    v_cos_f32 v193, v241
    v_sin_f32 v241, v241
    v_fmamk_f32 v242, v24, 0x3c200000, v26
    v_cos_f32 v194, v242
    v_sin_f32 v242, v242
    v_fmamk_f32 v243, v24, 0x3c300000, v26
    s_add_u32 m0, s40, 51200
    s_nop 0
    buffer_load_dwordx4 v4, s[12:15], s44 offen lds
    v_cos_f32 v195, v243
    v_sin_f32 v243, v243
    v_fmamk_f32 v244, v24, 0x3c800000, v26
    v_cos_f32 v196, v244
    v_sin_f32 v244, v244
    v_fmamk_f32 v245, v24, 0x3c880000, v26
    v_cos_f32 v197, v245
    v_sin_f32 v245, v245
    v_fmamk_f32 v246, v24, 0x3c900000, v26
    v_cos_f32 v198, v246
    v_sin_f32 v246, v246
    v_fmamk_f32 v247, v24, 0x3c980000, v26
    v_cos_f32 v199, v247
    v_sin_f32 v247, v247
    v_fmamk_f32 v248, v24, 0x3cc00000, v26
    v_cos_f32 v200, v248
    v_sin_f32 v248, v248
    s_add_u32 m0, s40, 55296
    s_nop 0
    buffer_load_dwordx4 v5, s[12:15], s44 offen lds
    v_fmamk_f32 v249, v24, 0x3cc80000, v26
    v_cos_f32 v201, v249
    v_sin_f32 v249, v249
    v_fmamk_f32 v250, v24, 0x3cd00000, v26
    v_cos_f32 v202, v250
    v_sin_f32 v250, v250
    v_fmamk_f32 v251, v24, 0x3cd80000, v26
    v_cos_f32 v203, v251
    v_sin_f32 v251, v251
    s_lshl2_add_u32 s61, s32, s51
    s_lshl_b32 s46, s31, 7
    v_add_u32 v28, s46, v27
    v_and_b32 v28, 0x7ff, v28
    v_xor_b32 v29, 0x400, v28
    s_and_b32 s46, s31, 15
    s_lshl2_add_u32 s47, s51, s32
    s_cmp_eq_u32 s46, s47
    s_cselect_b32 s60, 1, 0
    s_waitcnt vmcnt(11)
    s_barrier
    s_setprio 1
    s_add_u32 s52, s50, 2
    s_and_b32 s52, s52, 15
    s_mul_i32 s53, s52, 393216
    s_lshl_b32 s44, s52, 7
    s_add_u32 m0, s40, 104448
    s_nop 0
    buffer_load_dwordx4 v7, s[16:19], s53 offen lds
    ds_read_b64_tr_b16 v[64:65], v11 offset:0
    ds_read_b64_tr_b16 v[66:67], v11 offset:512
    ds_read_b64_tr_b16 v[68:69], v11 offset:1024
    ds_read_b64_tr_b16 v[70:71], v11 offset:1536
    ds_read_b64_tr_b16 v[72:73], v11 offset:2064
    ds_read_b64_tr_b16 v[74:75], v11 offset:2576
    s_add_u32 s45, s52, s63
    s_mul_i32 s45, s45, s62
    s_mov_b32 m0, s43
    s_nop 0
    buffer_load_dwordx4 v6, s[64:67], s45 offen lds
    ds_read_b64_tr_b16 v[76:77], v11 offset:3088
    ds_read_b64_tr_b16 v[78:79], v11 offset:3600
    s_waitcnt lgkmcnt(0)
    v_mfma_f32_32x32x16_bf16 v[108:123], v[64:67], v[212:215], 0
    v_mfma_f32_32x32x16_bf16 v[124:139], v[64:67], v[220:223], 0
    v_mfma_f32_32x32x16_bf16 v[108:123], v[68:71], v[216:219], v[108:123]
    s_add_u32 m0, s40, 112640
    s_add_u32 s45, s53, 2048
    buffer_load_dwordx4 v7, s[16:19], s45 offen lds
    v_mfma_f32_32x32x16_bf16 v[124:139], v[68:71], v[224:227], v[124:139]
    v_mfma_f32_32x32x16_bf16 v[108:123], v[72:75], v[228:231], v[108:123]
    v_mfma_f32_32x32x16_bf16 v[124:139], v[72:75], v[212:215], v[124:139]
    v_mfma_f32_32x32x16_bf16 v[108:123], v[76:79], v[232:235], v[108:123]
    v_mfma_f32_32x32x16_bf16 v[124:139], v[76:79], v[216:219], v[124:139]
    s_nop 10
    v_mul_f32 v18, v108, v188
    s_add_u32 m0, s40, 120832
    s_add_u32 s45, s53, 4096
    buffer_load_dwordx4 v7, s[16:19], s45 offen lds
    v_mul_f32 v20, v124, v188
    v_mul_f32 v19, v109, v189
    v_mul_f32 v21, v125, v189
    v_fmac_f32 v18, v124, v236
    v_fma_f32 v20, -v108, v236, v20
    v_fmac_f32 v19, v125, v237
    s_add_u32 m0, s40, 108544
    s_add_u32 s45, s53, 196608
    buffer_load_dwordx4 v7, s[16:19], s45 offen lds
    v_fma_f32 v21, -v109, v237, v21
    v_cvt_pk_bf16_f32 v32, v18, v19
    v_cvt_pk_bf16_f32 v40, v20, v21
    v_mul_f32 v204, v110, v190
    v_mul_f32 v206, v126, v190
    v_mul_f32 v205, v111, v191
    s_add_u32 m0, s40, 116736
    s_add_u32 s45, s53, 198656
    buffer_load_dwordx4 v7, s[16:19], s45 offen lds
    v_mul_f32 v207, v127, v191
    v_fmac_f32 v204, v126, v238
    v_fma_f32 v206, -v110, v238, v206
    v_fmac_f32 v205, v127, v239
    v_fma_f32 v207, -v111, v239, v207
    v_cvt_pk_bf16_f32 v33, v204, v205
    s_add_u32 m0, s40, 124928
    s_add_u32 s45, s53, 200704
    buffer_load_dwordx4 v7, s[16:19], s45 offen lds
    v_cvt_pk_bf16_f32 v41, v206, v207
    v_mul_f32 v18, v112, v192
    v_mul_f32 v20, v128, v192
    v_mul_f32 v19, v113, v193
    v_mul_f32 v21, v129, v193
    v_fmac_f32 v18, v128, v240
    s_add_u32 m0, s40, 86016
    s_nop 0
    buffer_load_dwordx4 v2, s[12:15], s44 offen lds
    v_fma_f32 v20, -v112, v240, v20
    v_fmac_f32 v19, v129, v241
    v_fma_f32 v21, -v113, v241, v21
    v_cvt_pk_bf16_f32 v34, v18, v19
    v_cvt_pk_bf16_f32 v42, v20, v21
    v_mul_f32 v204, v114, v194
    s_add_u32 m0, s40, 90112
    s_nop 0
    buffer_load_dwordx4 v3, s[12:15], s44 offen lds
    v_mul_f32 v206, v130, v194
    v_mul_f32 v205, v115, v195
    v_mul_f32 v207, v131, v195
    v_fmac_f32 v204, v130, v242
    v_fma_f32 v206, -v114, v242, v206
    v_fmac_f32 v205, v131, v243
    s_add_u32 m0, s40, 94208
    s_nop 0
    buffer_load_dwordx4 v4, s[12:15], s44 offen lds
    v_fma_f32 v207, -v115, v243, v207
    v_cvt_pk_bf16_f32 v35, v204, v205
    v_cvt_pk_bf16_f32 v43, v206, v207
    v_mul_f32 v18, v116, v196
    v_mul_f32 v20, v132, v196
    v_mul_f32 v19, v117, v197
    s_add_u32 m0, s40, 98304
    s_nop 0
    buffer_load_dwordx4 v5, s[12:15], s44 offen lds
    v_mul_f32 v21, v133, v197
    v_fmac_f32 v18, v132, v244
    v_fma_f32 v20, -v116, v244, v20
    v_fmac_f32 v19, v133, v245
    v_fma_f32 v21, -v117, v245, v21
    s_waitcnt vmcnt(11)
    s_barrier
    s_add_u32 s52, s50, 3
    s_and_b32 s52, s52, 15
    s_mul_i32 s53, s52, 393216
    s_lshl_b32 s44, s52, 7
    s_add_u32 m0, s40, 18432
    s_nop 0
    buffer_load_dwordx4 v7, s[16:19], s53 offen lds
    v_cvt_pk_bf16_f32 v36, v18, v19
    v_cvt_pk_bf16_f32 v44, v20, v21
    v_mul_f32 v204, v118, v198
    v_mul_f32 v206, v134, v198
    v_mul_f32 v205, v119, v199
    v_mul_f32 v207, v135, v199
    s_add_u32 s45, s52, s63
    s_mul_i32 s45, s45, s62
    s_mov_b32 m0, s41
    s_nop 0
    buffer_load_dwordx4 v6, s[64:67], s45 offen lds
    v_fmac_f32 v204, v134, v246
    v_fma_f32 v206, -v118, v246, v206
    v_fmac_f32 v205, v135, v247
    v_fma_f32 v207, -v119, v247, v207
    v_cvt_pk_bf16_f32 v37, v204, v205
    v_cvt_pk_bf16_f32 v45, v206, v207
    s_add_u32 m0, s40, 26624
    s_add_u32 s45, s53, 2048
    buffer_load_dwordx4 v7, s[16:19], s45 offen lds
    v_mul_f32 v18, v120, v200
    v_mul_f32 v20, v136, v200
    v_mul_f32 v19, v121, v201
    v_mul_f32 v21, v137, v201
    v_fmac_f32 v18, v136, v248
    v_fma_f32 v20, -v120, v248, v20
    s_add_u32 m0, s40, 34816
    s_add_u32 s45, s53, 4096
    buffer_load_dwordx4 v7, s[16:19], s45 offen lds
    v_fmac_f32 v19, v137, v249
    v_fma_f32 v21, -v121, v249, v21
    v_cvt_pk_bf16_f32 v38, v18, v19
    v_cvt_pk_bf16_f32 v46, v20, v21
    v_mul_f32 v204, v122, v202
    v_mul_f32 v206, v138, v202
    s_add_u32 m0, s40, 22528
    s_add_u32 s45, s53, 196608
    buffer_load_dwordx4 v7, s[16:19], s45 offen lds
    v_mul_f32 v205, v123, v203
    v_mul_f32 v207, v139, v203
    v_fmac_f32 v204, v138, v250
    v_fma_f32 v206, -v122, v250, v206
    v_fmac_f32 v205, v139, v251
    v_fma_f32 v207, -v123, v251, v207
    s_add_u32 m0, s40, 30720
    s_add_u32 s45, s53, 198656
    buffer_load_dwordx4 v7, s[16:19], s45 offen lds
    v_cvt_pk_bf16_f32 v39, v204, v205
    v_cvt_pk_bf16_f32 v47, v206, v207
    v_mfma_f32_32x32x16_bf16 v[108:123], v[32:35], v[212:215], 0
    v_mfma_f32_32x32x16_bf16 v[124:139], v[32:35], v[220:223], 0
    v_mfma_f32_32x32x16_bf16 v[108:123], v[36:39], v[216:219], v[108:123]
    s_add_u32 m0, s40, 38912
    s_add_u32 s45, s53, 200704
    buffer_load_dwordx4 v7, s[16:19], s45 offen lds
    v_mfma_f32_32x32x16_bf16 v[124:139], v[36:39], v[224:227], v[124:139]
    v_mfma_f32_32x32x16_bf16 v[108:123], v[40:43], v[228:231], v[108:123]
    v_mfma_f32_32x32x16_bf16 v[124:139], v[40:43], v[212:215], v[124:139]
    v_mfma_f32_32x32x16_bf16 v[108:123], v[44:47], v[232:235], v[108:123]
    v_mfma_f32_32x32x16_bf16 v[124:139], v[44:47], v[216:219], v[124:139]
    s_nop 10
    v_cvt_pk_bf16_f32 v172, v108, v109
    s_add_u32 m0, s40, 0
    s_nop 0
    buffer_load_dwordx4 v2, s[12:15], s44 offen lds
    v_cvt_pk_bf16_f32 v173, v110, v111
    v_cvt_pk_bf16_f32 v174, v112, v113
    v_cvt_pk_bf16_f32 v175, v114, v115
    v_cvt_pk_bf16_f32 v176, v116, v117
    v_cvt_pk_bf16_f32 v177, v118, v119
    v_cvt_pk_bf16_f32 v178, v120, v121
    s_add_u32 m0, s40, 4096
    s_nop 0
    buffer_load_dwordx4 v3, s[12:15], s44 offen lds
    v_cvt_pk_bf16_f32 v179, v122, v123
    ds_write_b128 v12, v[172:175] offset:0
    ds_write_b128 v13, v[176:179] offset:0
    v_cvt_pk_bf16_f32 v180, v124, v125
    v_cvt_pk_bf16_f32 v181, v126, v127
    v_cvt_pk_bf16_f32 v182, v128, v129
    s_add_u32 m0, s40, 8192
    s_nop 0
    buffer_load_dwordx4 v4, s[12:15], s44 offen lds
    v_cvt_pk_bf16_f32 v183, v130, v131
    v_cvt_pk_bf16_f32 v184, v132, v133
    v_cvt_pk_bf16_f32 v185, v134, v135
    v_cvt_pk_bf16_f32 v186, v136, v137
    v_cvt_pk_bf16_f32 v187, v138, v139
    ds_write_b128 v12, v[180:183] offset:2064
    s_add_u32 m0, s40, 12288
    s_nop 0
    buffer_load_dwordx4 v5, s[12:15], s44 offen lds
    ds_write_b128 v13, v[184:187] offset:2064
    ds_read_b128 v[64:67], v14 offset:0
    ds_read_b128 v[68:71], v15 offset:1024
    ds_read_b128 v[72:75], v14 offset:2064
    ds_read_b128 v[76:79], v15 offset:3088
    s_waitcnt vmcnt(11)
    s_barrier
    s_add_u32 s52, s50, 4
    s_and_b32 s52, s52, 15
    s_mul_i32 s53, s52, 393216
    s_lshl_b32 s44, s52, 7
    s_add_u32 m0, s40, 61440
    s_nop 0
    buffer_load_dwordx4 v7, s[16:19], s53 offen lds
    s_add_u32 s45, s52, s63
    s_mul_i32 s45, s45, s62
    s_mov_b32 m0, s42
    s_nop 0
    buffer_load_dwordx4 v6, s[64:67], s45 offen lds
    s_add_u32 m0, s40, 69632
    s_add_u32 s45, s53, 2048
    buffer_load_dwordx4 v7, s[16:19], s45 offen lds
    s_add_u32 m0, s40, 77824
    s_add_u32 s45, s53, 4096
    buffer_load_dwordx4 v7, s[16:19], s45 offen lds
    s_add_u32 m0, s40, 65536
    s_add_u32 s45, s53, 196608
    buffer_load_dwordx4 v7, s[16:19], s45 offen lds
    s_add_u32 m0, s40, 73728
    s_add_u32 s45, s53, 198656
    buffer_load_dwordx4 v7, s[16:19], s45 offen lds
    s_add_u32 m0, s40, 81920
    s_add_u32 s45, s53, 200704
    buffer_load_dwordx4 v7, s[16:19], s45 offen lds
    s_add_u32 m0, s40, 43008
    s_nop 0
    buffer_load_dwordx4 v2, s[12:15], s44 offen lds
    s_add_u32 m0, s40, 47104
    s_nop 0
    buffer_load_dwordx4 v3, s[12:15], s44 offen lds
    s_add_u32 m0, s40, 51200
    s_nop 0
    buffer_load_dwordx4 v4, s[12:15], s44 offen lds
    s_add_u32 m0, s40, 55296
    s_nop 0
    buffer_load_dwordx4 v5, s[12:15], s44 offen lds
    s_waitcnt vmcnt(11)
    s_barrier
    s_add_u32 s52, s50, 5
    s_and_b32 s52, s52, 15
    s_mul_i32 s53, s52, 393216
    s_lshl_b32 s44, s52, 7
    s_add_u32 m0, s40, 104448
    s_nop 0
    buffer_load_dwordx4 v7, s[16:19], s53 offen lds
    s_add_u32 s45, s52, s63
    s_mul_i32 s45, s45, s62
    s_mov_b32 m0, s43
    s_nop 0
    buffer_load_dwordx4 v6, s[64:67], s45 offen lds
    s_add_u32 m0, s40, 112640
    s_add_u32 s45, s53, 2048
    buffer_load_dwordx4 v7, s[16:19], s45 offen lds
    s_add_u32 m0, s40, 120832
    s_add_u32 s45, s53, 4096
    buffer_load_dwordx4 v7, s[16:19], s45 offen lds
    s_add_u32 m0, s40, 108544
    s_add_u32 s45, s53, 196608
    buffer_load_dwordx4 v7, s[16:19], s45 offen lds
    s_add_u32 m0, s40, 116736
    s_add_u32 s45, s53, 198656
    buffer_load_dwordx4 v7, s[16:19], s45 offen lds
    s_add_u32 m0, s40, 124928
    s_add_u32 s45, s53, 200704
    buffer_load_dwordx4 v7, s[16:19], s45 offen lds
    s_add_u32 m0, s40, 86016
    s_nop 0
    buffer_load_dwordx4 v2, s[12:15], s44 offen lds
    s_add_u32 m0, s40, 90112
    s_nop 0
    buffer_load_dwordx4 v3, s[12:15], s44 offen lds
    s_add_u32 m0, s40, 94208
    s_nop 0
    buffer_load_dwordx4 v4, s[12:15], s44 offen lds
    s_add_u32 m0, s40, 98304
    s_nop 0
    buffer_load_dwordx4 v5, s[12:15], s44 offen lds
    s_waitcnt vmcnt(11)
    s_barrier
    s_add_u32 s52, s50, 6
    s_and_b32 s52, s52, 15
    s_mul_i32 s53, s52, 393216
    s_lshl_b32 s44, s52, 7
    s_add_u32 m0, s40, 18432
    s_nop 0
    buffer_load_dwordx4 v7, s[16:19], s53 offen lds
    v_and_b32 v18, 7, v0
    v_lshlrev_b32 v19, 2, v18
    v_add_u32 v19, 163072, v19
    s_add_u32 s45, s52, s63
    s_mul_i32 s45, s45, s62
    s_mov_b32 m0, s41
    s_nop 0
    buffer_load_dwordx4 v6, s[64:67], s45 offen lds
    ds_read2_b32 v[20:21], v19 offset0:0 offset1:8
    ds_read2_b32 v[22:23], v19 offset0:16 offset1:24
    s_add_u32 m0, s40, 26624
    s_add_u32 s45, s53, 2048
    buffer_load_dwordx4 v7, s[16:19], s45 offen lds
    s_waitcnt lgkmcnt(0)
    v_add_f32 v20, v20, v21
    s_add_u32 m0, s40, 34816
    s_add_u32 s45, s53, 4096
    buffer_load_dwordx4 v7, s[16:19], s45 offen lds
    v_add_f32 v22, v22, v23
    v_add_f32 v20, v20, v22
    s_add_u32 m0, s40, 22528
    s_add_u32 s45, s53, 196608
    buffer_load_dwordx4 v7, s[16:19], s45 offen lds
    v_cvt_pk_bf16_f32 v20, v20, v20
    v_lshlrev_b32 v20, 16, v20
    s_add_u32 m0, s40, 30720
    s_add_u32 s45, s53, 198656
    buffer_load_dwordx4 v7, s[16:19], s45 offen lds
    v_mul_f32 v20, 0xbfb8aa3b, v20
    v_exp_f32 v20, v20
    s_nop 0
    v_add_f32 v20, 1.0, v20
    s_add_u32 m0, s40, 38912
    s_add_u32 s45, s53, 200704
    buffer_load_dwordx4 v7, s[16:19], s45 offen lds
    v_rcp_f32 v20, v20
    s_nop 0
    v_cvt_pk_bf16_f32 v20, v20, v20
    s_add_u32 m0, s40, 0
    s_nop 0
    buffer_load_dwordx4 v2, s[12:15], s44 offen lds
    v_lshlrev_b32 v20, 16, v20
    s_lshl2_add_u32 s46, s31, s32
    s_add_u32 m0, s40, 4096
    s_nop 0
    buffer_load_dwordx4 v3, s[12:15], s44 offen lds
    s_lshl_b32 s46, s46, 7
    s_add_u32 s46, s46, 12582912
    s_add_u32 m0, s40, 8192
    s_nop 0
    buffer_load_dwordx4 v4, s[12:15], s44 offen lds
    s_lshl_b32 s47, s51, 30
    v_lshlrev_b32 v19, 2, v0
    s_add_u32 m0, s40, 12288
    s_nop 0
    buffer_load_dwordx4 v5, s[12:15], s44 offen lds
    v_or_b32 v19, s47, v19
    s_mov_b32 exec_hi, 0
    buffer_store_dword v20, v19, s[20:23], s46 offen sc1
    s_mov_b64 exec, -1
    s_waitcnt vmcnt(12)
    s_barrier
    s_add_u32 s52, s50, 7
    s_and_b32 s52, s52, 15
    s_mul_i32 s53, s52, 393216
    s_lshl_b32 s44, s52, 7
    s_add_u32 m0, s40, 61440
    s_nop 0
    buffer_load_dwordx4 v7, s[16:19], s53 offen lds
    s_mov_b32 s46, s61
    s_add_u32 s45, s52, s63
    s_mul_i32 s45, s45, s62
    s_mov_b32 m0, s42
    s_nop 0
    buffer_load_dwordx4 v6, s[64:67], s45 offen lds
    s_lshl_b32 s46, s46, 6
    s_add_u32 m0, s40, 69632
    s_add_u32 s45, s53, 2048
    buffer_load_dwordx4 v7, s[16:19], s45 offen lds
    s_add_u32 m0, s40, 77824
    s_add_u32 s45, s53, 4096
    buffer_load_dwordx4 v7, s[16:19], s45 offen lds
    s_add_u32 s46, s46, s31
    s_add_u32 m0, s40, 65536
    s_add_u32 s45, s53, 196608
    buffer_load_dwordx4 v7, s[16:19], s45 offen lds
    s_add_u32 m0, s40, 73728
    s_add_u32 s45, s53, 198656
    buffer_load_dwordx4 v7, s[16:19], s45 offen lds
    s_lshl_b32 s46, s46, 12
    s_add_u32 m0, s40, 81920
    s_add_u32 s45, s53, 200704
    buffer_load_dwordx4 v7, s[16:19], s45 offen lds
    s_add_u32 m0, s40, 43008
    s_nop 0
    buffer_load_dwordx4 v2, s[12:15], s44 offen lds
    s_add_u32 s46, s46, 4194304
    s_add_u32 m0, s40, 47104
    s_nop 0
    buffer_load_dwordx4 v3, s[12:15], s44 offen lds
    s_add_u32 m0, s40, 51200
    s_nop 0
    buffer_load_dwordx4 v4, s[12:15], s44 offen lds
    s_waitcnt lgkmcnt(0)
    s_add_u32 m0, s40, 55296
    s_nop 0
    buffer_load_dwordx4 v5, s[12:15], s44 offen lds
    s_waitcnt vmcnt(12)
    s_barrier
    s_add_u32 s52, s50, 8
    s_and_b32 s52, s52, 15
    s_mul_i32 s53, s52, 393216
    s_lshl_b32 s44, s52, 7
    s_add_u32 m0, s40, 104448
    s_nop 0
    buffer_load_dwordx4 v7, s[16:19], s53 offen lds
    s_add_u32 s45, s52, s63
    s_mul_i32 s45, s45, s62
    s_mov_b32 m0, s43
    s_nop 0
    buffer_load_dwordx4 v6, s[64:67], s45 offen lds
    s_add_u32 m0, s40, 112640
    s_add_u32 s45, s53, 2048
    buffer_load_dwordx4 v7, s[16:19], s45 offen lds
    s_add_u32 m0, s40, 120832
    s_add_u32 s45, s53, 4096
    buffer_load_dwordx4 v7, s[16:19], s45 offen lds
    s_add_u32 m0, s40, 108544
    s_add_u32 s45, s53, 196608
    buffer_load_dwordx4 v7, s[16:19], s45 offen lds
    s_add_u32 m0, s40, 116736
    s_add_u32 s45, s53, 198656
    buffer_load_dwordx4 v7, s[16:19], s45 offen lds
    s_add_u32 m0, s40, 124928
    s_add_u32 s45, s53, 200704
    buffer_load_dwordx4 v7, s[16:19], s45 offen lds
    s_add_u32 m0, s40, 86016
    s_nop 0
    buffer_load_dwordx4 v2, s[12:15], s44 offen lds
    s_add_u32 m0, s40, 90112
    s_nop 0
    buffer_load_dwordx4 v3, s[12:15], s44 offen lds
    s_add_u32 m0, s40, 94208
    s_nop 0
    buffer_load_dwordx4 v4, s[12:15], s44 offen lds
    s_add_u32 m0, s40, 98304
    s_nop 0
    buffer_load_dwordx4 v5, s[12:15], s44 offen lds
    buffer_store_dwordx4 v[64:67], v27, s[20:23], s46 offen offset:0 sc1
    buffer_store_dwordx4 v[68:71], v27, s[20:23], s46 offen offset:1024 sc1
    buffer_store_dwordx4 v[72:75], v27, s[20:23], s46 offen offset:2048 sc1
    buffer_store_dwordx4 v[76:79], v27, s[20:23], s46 offen offset:3072 sc1
    s_waitcnt vmcnt(15)
    s_barrier
    s_add_u32 s52, s50, 9
    s_and_b32 s52, s52, 15
    s_mul_i32 s53, s52, 393216
    s_lshl_b32 s44, s52, 7
    s_add_u32 m0, s40, 18432
    s_nop 0
    buffer_load_dwordx4 v7, s[16:19], s53 offen lds
    s_add_u32 s45, s52, s63
    s_mul_i32 s45, s45, s62
    s_mov_b32 m0, s41
    s_nop 0
    buffer_load_dwordx4 v6, s[64:67], s45 offen lds
    s_add_u32 m0, s40, 26624
    s_add_u32 s45, s53, 2048
    buffer_load_dwordx4 v7, s[16:19], s45 offen lds
    s_add_u32 m0, s40, 34816
    s_add_u32 s45, s53, 4096
    buffer_load_dwordx4 v7, s[16:19], s45 offen lds
    s_add_u32 m0, s40, 22528
    s_add_u32 s45, s53, 196608
    buffer_load_dwordx4 v7, s[16:19], s45 offen lds
    s_add_u32 m0, s40, 30720
    s_add_u32 s45, s53, 198656
    buffer_load_dwordx4 v7, s[16:19], s45 offen lds
    s_add_u32 m0, s40, 38912
    s_add_u32 s45, s53, 200704
    buffer_load_dwordx4 v7, s[16:19], s45 offen lds
    s_add_u32 m0, s40, 0
    s_nop 0
    buffer_load_dwordx4 v2, s[12:15], s44 offen lds
    s_add_u32 m0, s40, 4096
    s_nop 0
    buffer_load_dwordx4 v3, s[12:15], s44 offen lds
    s_add_u32 m0, s40, 8192
    s_nop 0
    buffer_load_dwordx4 v4, s[12:15], s44 offen lds
    s_add_u32 m0, s40, 12288
    s_nop 0
    buffer_load_dwordx4 v5, s[12:15], s44 offen lds
    s_waitcnt vmcnt(15)
    s_barrier
    s_add_u32 s52, s50, 10
    s_and_b32 s52, s52, 15
    s_mul_i32 s53, s52, 393216
    s_lshl_b32 s44, s52, 7
    s_add_u32 m0, s40, 61440
    s_nop 0
    buffer_load_dwordx4 v7, s[16:19], s53 offen lds
    s_add_u32 s45, s52, s63
    s_mul_i32 s45, s45, s62
    s_mov_b32 m0, s42
    s_nop 0
    buffer_load_dwordx4 v6, s[64:67], s45 offen lds
    s_add_u32 m0, s40, 69632
    s_add_u32 s45, s53, 2048
    buffer_load_dwordx4 v7, s[16:19], s45 offen lds
    s_add_u32 m0, s40, 77824
    s_add_u32 s45, s53, 4096
    buffer_load_dwordx4 v7, s[16:19], s45 offen lds
    s_add_u32 m0, s40, 65536
    s_add_u32 s45, s53, 196608
    buffer_load_dwordx4 v7, s[16:19], s45 offen lds
    s_add_u32 m0, s40, 73728
    s_add_u32 s45, s53, 198656
    buffer_load_dwordx4 v7, s[16:19], s45 offen lds
    s_add_u32 m0, s40, 81920
    s_add_u32 s45, s53, 200704
    buffer_load_dwordx4 v7, s[16:19], s45 offen lds
    s_add_u32 m0, s40, 43008
    s_nop 0
    buffer_load_dwordx4 v2, s[12:15], s44 offen lds
    s_add_u32 m0, s40, 47104
    s_nop 0
    buffer_load_dwordx4 v3, s[12:15], s44 offen lds
    s_add_u32 m0, s40, 51200
    s_nop 0
    buffer_load_dwordx4 v4, s[12:15], s44 offen lds
    s_add_u32 m0, s40, 55296
    s_nop 0
    buffer_load_dwordx4 v5, s[12:15], s44 offen lds
    s_waitcnt vmcnt(11)
    s_barrier
    s_add_u32 s52, s50, 11
    s_and_b32 s52, s52, 15
    s_mul_i32 s53, s52, 393216
    s_lshl_b32 s44, s52, 7
    s_add_u32 m0, s40, 104448
    s_nop 0
    buffer_load_dwordx4 v7, s[16:19], s53 offen lds
    s_add_u32 s45, s52, s63
    s_mul_i32 s45, s45, s62
    s_mov_b32 m0, s43
    s_nop 0
    buffer_load_dwordx4 v6, s[64:67], s45 offen lds
    s_add_u32 m0, s40, 112640
    s_add_u32 s45, s53, 2048
    buffer_load_dwordx4 v7, s[16:19], s45 offen lds
    s_add_u32 m0, s40, 120832
    s_add_u32 s45, s53, 4096
    buffer_load_dwordx4 v7, s[16:19], s45 offen lds
    s_add_u32 m0, s40, 108544
    s_add_u32 s45, s53, 196608
    buffer_load_dwordx4 v7, s[16:19], s45 offen lds
    s_add_u32 m0, s40, 116736
    s_add_u32 s45, s53, 198656
    buffer_load_dwordx4 v7, s[16:19], s45 offen lds
    s_add_u32 m0, s40, 124928
    s_add_u32 s45, s53, 200704
    buffer_load_dwordx4 v7, s[16:19], s45 offen lds
    s_add_u32 m0, s40, 86016
    s_nop 0
    buffer_load_dwordx4 v2, s[12:15], s44 offen lds
    s_add_u32 m0, s40, 90112
    s_nop 0
    buffer_load_dwordx4 v3, s[12:15], s44 offen lds
    s_add_u32 m0, s40, 94208
    s_nop 0
    buffer_load_dwordx4 v4, s[12:15], s44 offen lds
    s_add_u32 m0, s40, 98304
    s_nop 0
    buffer_load_dwordx4 v5, s[12:15], s44 offen lds
    s_waitcnt vmcnt(11)
    s_barrier
    s_add_u32 s52, s50, 12
    s_and_b32 s52, s52, 15
    s_mul_i32 s53, s52, 393216
    s_lshl_b32 s44, s52, 7
    s_add_u32 m0, s40, 18432
    s_nop 0
    buffer_load_dwordx4 v7, s[16:19], s53 offen lds
    s_add_u32 s45, s52, s63
    s_mul_i32 s45, s45, s62
    s_mov_b32 m0, s41
    s_nop 0
    buffer_load_dwordx4 v6, s[64:67], s45 offen lds
    s_add_u32 m0, s40, 26624
    s_add_u32 s45, s53, 2048
    buffer_load_dwordx4 v7, s[16:19], s45 offen lds
    s_add_u32 m0, s40, 34816
    s_add_u32 s45, s53, 4096
    buffer_load_dwordx4 v7, s[16:19], s45 offen lds
    s_add_u32 m0, s40, 22528
    s_add_u32 s45, s53, 196608
    buffer_load_dwordx4 v7, s[16:19], s45 offen lds
    s_add_u32 m0, s40, 30720
    s_add_u32 s45, s53, 198656
    buffer_load_dwordx4 v7, s[16:19], s45 offen lds
    s_add_u32 m0, s40, 38912
    s_add_u32 s45, s53, 200704
    buffer_load_dwordx4 v7, s[16:19], s45 offen lds
    s_add_u32 m0, s40, 0
    s_nop 0
    buffer_load_dwordx4 v2, s[12:15], s44 offen lds
    s_add_u32 m0, s40, 4096
    s_nop 0
    buffer_load_dwordx4 v3, s[12:15], s44 offen lds
    s_add_u32 m0, s40, 8192
    s_nop 0
    buffer_load_dwordx4 v4, s[12:15], s44 offen lds
    s_add_u32 m0, s40, 12288
    s_nop 0
    buffer_load_dwordx4 v5, s[12:15], s44 offen lds
    s_waitcnt vmcnt(11)
    s_barrier
    s_add_u32 s52, s50, 13
    s_and_b32 s52, s52, 15
    s_mul_i32 s53, s52, 393216
    s_lshl_b32 s44, s52, 7
    s_add_u32 m0, s40, 61440
    s_nop 0
    buffer_load_dwordx4 v7, s[16:19], s53 offen lds
    s_add_u32 s45, s52, s63
    s_mul_i32 s45, s45, s62
    s_mov_b32 m0, s42
    s_nop 0
    buffer_load_dwordx4 v6, s[64:67], s45 offen lds
    s_add_u32 m0, s40, 69632
    s_add_u32 s45, s53, 2048
    buffer_load_dwordx4 v7, s[16:19], s45 offen lds
    s_add_u32 m0, s40, 77824
    s_add_u32 s45, s53, 4096
    buffer_load_dwordx4 v7, s[16:19], s45 offen lds
    s_add_u32 m0, s40, 65536
    s_add_u32 s45, s53, 196608
    buffer_load_dwordx4 v7, s[16:19], s45 offen lds
    s_add_u32 m0, s40, 73728
    s_add_u32 s45, s53, 198656
    buffer_load_dwordx4 v7, s[16:19], s45 offen lds
    s_add_u32 m0, s40, 81920
    s_add_u32 s45, s53, 200704
    buffer_load_dwordx4 v7, s[16:19], s45 offen lds
    s_add_u32 m0, s40, 43008
    s_nop 0
    buffer_load_dwordx4 v2, s[12:15], s44 offen lds
    s_add_u32 m0, s40, 47104
    s_nop 0
    buffer_load_dwordx4 v3, s[12:15], s44 offen lds
    s_add_u32 m0, s40, 51200
    s_nop 0
    buffer_load_dwordx4 v4, s[12:15], s44 offen lds
    s_add_u32 m0, s40, 55296
    s_nop 0
    buffer_load_dwordx4 v5, s[12:15], s44 offen lds
    s_waitcnt vmcnt(11)
    s_barrier
    s_add_u32 s52, s50, 14
    s_and_b32 s52, s52, 15
    s_mul_i32 s53, s52, 393216
    s_lshl_b32 s44, s52, 7
    s_add_u32 m0, s40, 104448
    s_nop 0
    buffer_load_dwordx4 v7, s[16:19], s53 offen lds
    s_waitcnt lgkmcnt(0)
    s_add_u32 s45, s52, s63
    s_mul_i32 s45, s45, s62
    s_mov_b32 m0, s43
    s_nop 0
    buffer_load_dwordx4 v6, s[64:67], s45 offen lds
    s_add_u32 m0, s40, 112640
    s_add_u32 s45, s53, 2048
    buffer_load_dwordx4 v7, s[16:19], s45 offen lds
    s_add_u32 m0, s40, 120832
    s_add_u32 s45, s53, 4096
    buffer_load_dwordx4 v7, s[16:19], s45 offen lds
    s_add_u32 m0, s40, 108544
    s_add_u32 s45, s53, 196608
    buffer_load_dwordx4 v7, s[16:19], s45 offen lds
    s_add_u32 m0, s40, 116736
    s_add_u32 s45, s53, 198656
    buffer_load_dwordx4 v7, s[16:19], s45 offen lds
    s_add_u32 m0, s40, 124928
    s_add_u32 s45, s53, 200704
    buffer_load_dwordx4 v7, s[16:19], s45 offen lds
    s_add_u32 m0, s40, 86016
    s_nop 0
    buffer_load_dwordx4 v2, s[12:15], s44 offen lds
    s_add_u32 m0, s40, 90112
    s_nop 0
    buffer_load_dwordx4 v3, s[12:15], s44 offen lds
    s_add_u32 m0, s40, 94208
    s_nop 0
    buffer_load_dwordx4 v4, s[12:15], s44 offen lds
    s_add_u32 m0, s40, 98304
    s_nop 0
    buffer_load_dwordx4 v5, s[12:15], s44 offen lds
    s_waitcnt vmcnt(11)
    s_barrier
    s_add_u32 s52, s50, 15
    s_and_b32 s52, s52, 15
    s_mul_i32 s53, s52, 393216
    s_lshl_b32 s44, s52, 7
    s_add_u32 m0, s40, 18432
    s_nop 0
    buffer_load_dwordx4 v7, s[16:19], s53 offen lds
    s_add_u32 s45, s52, s63
    s_mul_i32 s45, s45, s62
    s_mov_b32 m0, s41
    s_nop 0
    buffer_load_dwordx4 v6, s[64:67], s45 offen lds
    s_add_u32 m0, s40, 26624
    s_add_u32 s45, s53, 2048
    buffer_load_dwordx4 v7, s[16:19], s45 offen lds
    s_add_u32 m0, s40, 34816
    s_add_u32 s45, s53, 4096
    buffer_load_dwordx4 v7, s[16:19], s45 offen lds
    s_add_u32 m0, s40, 22528
    s_add_u32 s45, s53, 196608
    buffer_load_dwordx4 v7, s[16:19], s45 offen lds
    s_add_u32 m0, s40, 30720
    s_add_u32 s45, s53, 198656
    buffer_load_dwordx4 v7, s[16:19], s45 offen lds
    s_add_u32 m0, s40, 38912
    s_add_u32 s45, s53, 200704
    buffer_load_dwordx4 v7, s[16:19], s45 offen lds
    s_add_u32 m0, s40, 0
    s_nop 0
    buffer_load_dwordx4 v2, s[12:15], s44 offen lds
    s_add_u32 m0, s40, 4096
    s_nop 0
    buffer_load_dwordx4 v3, s[12:15], s44 offen lds
    s_add_u32 m0, s40, 8192
    s_nop 0
    buffer_load_dwordx4 v4, s[12:15], s44 offen lds
    s_add_u32 m0, s40, 12288
    s_nop 0
    buffer_load_dwordx4 v5, s[12:15], s44 offen lds
    s_waitcnt vmcnt(11)
    s_barrier
    s_setprio 0
    s_waitcnt vmcnt(0)
    v_mov_b32 v211, 1
    ds_write_b32 v255, v211
    s_and_b32 s57, s57, 0xffff
    s_mov_b32 s58, 0x200000
    s_mov_b32 s59, 0x00020000
    s_lshl2_add_u32 s55, s34, s51
    s_lshl_b32 s55, s55, 14
    s_lshr_b32 s54, s33, 2
    s_lshl3_add_u32 s54, s54, 12
    v_and_b32 v253, 7, v0
    v_add_u32 v253, s54, v253
    v_and_b32 v253, 15, v253
    v_lshlrev_b32 v253, 7, v253
    v_lshrrev_b32 v254, 3, v0
    v_lshl_add_u32 v253, v254, 11, v253
    buffer_load_dword v252, v253, s[56:59], s55 offen
    s_branch K1_AGAIN
K1_TAIL:
    ds_read_b64_tr_b16 v[64:65], v11 offset:0
    ds_read_b64_tr_b16 v[66:67], v11 offset:512
    ds_read_b64_tr_b16 v[68:69], v11 offset:1024
    ds_read_b64_tr_b16 v[70:71], v11 offset:1536
    ds_read_b64_tr_b16 v[72:73], v11 offset:2064
    ds_read_b64_tr_b16 v[74:75], v11 offset:2576
    ds_read_b64_tr_b16 v[76:77], v11 offset:3088
    ds_read_b64_tr_b16 v[78:79], v11 offset:3600
    s_waitcnt lgkmcnt(0)
    v_mfma_f32_32x32x16_bf16 v[108:123], v[64:67], v[212:215], 0
    v_mfma_f32_32x32x16_bf16 v[124:139], v[64:67], v[220:223], 0
    v_mfma_f32_32x32x16_bf16 v[108:123], v[68:71], v[216:219], v[108:123]
    v_mfma_f32_32x32x16_bf16 v[124:139], v[68:71], v[224:227], v[124:139]
    v_mfma_f32_32x32x16_bf16 v[108:123], v[72:75], v[228:231], v[108:123]
    v_mfma_f32_32x32x16_bf16 v[124:139], v[72:75], v[212:215], v[124:139]
    v_mfma_f32_32x32x16_bf16 v[108:123], v[76:79], v[232:235], v[108:123]
    v_mfma_f32_32x32x16_bf16 v[124:139], v[76:79], v[216:219], v[124:139]
    s_nop 10
    v_mul_f32 v18, v108, v188
    v_mul_f32 v20, v124, v188
    v_mul_f32 v19, v109, v189
    v_mul_f32 v21, v125, v189
    v_fmac_f32 v18, v124, v236
    v_fma_f32 v20, -v108, v236, v20
    v_fmac_f32 v19, v125, v237
    v_fma_f32 v21, -v109, v237, v21
    v_cvt_pk_bf16_f32 v32, v18, v19
    v_cvt_pk_bf16_f32 v40, v20, v21
    v_mul_f32 v204, v110, v190
    v_mul_f32 v206, v126, v190
    v_mul_f32 v205, v111, v191
    v_mul_f32 v207, v127, v191
    v_fmac_f32 v204, v126, v238
    v_fma_f32 v206, -v110, v238, v206
    v_fmac_f32 v205, v127, v239
    v_fma_f32 v207, -v111, v239, v207
    v_cvt_pk_bf16_f32 v33, v204, v205
    v_cvt_pk_bf16_f32 v41, v206, v207
    v_mul_f32 v18, v112, v192
    v_mul_f32 v20, v128, v192
    v_mul_f32 v19, v113, v193
    v_mul_f32 v21, v129, v193
    v_fmac_f32 v18, v128, v240
    v_fma_f32 v20, -v112, v240, v20
    v_fmac_f32 v19, v129, v241
    v_fma_f32 v21, -v113, v241, v21
    v_cvt_pk_bf16_f32 v34, v18, v19
    v_cvt_pk_bf16_f32 v42, v20, v21
    v_mul_f32 v204, v114, v194
    v_mul_f32 v206, v130, v194
    v_mul_f32 v205, v115, v195
    v_mul_f32 v207, v131, v195
    v_fmac_f32 v204, v130, v242
    v_fma_f32 v206, -v114, v242, v206
    v_fmac_f32 v205, v131, v243
    v_fma_f32 v207, -v115, v243, v207
    v_cvt_pk_bf16_f32 v35, v204, v205
    v_cvt_pk_bf16_f32 v43, v206, v207
    v_mul_f32 v18, v116, v196
    v_mul_f32 v20, v132, v196
    v_mul_f32 v19, v117, v197
    v_mul_f32 v21, v133, v197
    v_fmac_f32 v18, v132, v244
    v_fma_f32 v20, -v116, v244, v20
    v_fmac_f32 v19, v133, v245
    v_fma_f32 v21, -v117, v245, v21
    v_cvt_pk_bf16_f32 v36, v18, v19
    v_cvt_pk_bf16_f32 v44, v20, v21
    v_mul_f32 v204, v118, v198
    v_mul_f32 v206, v134, v198
    v_mul_f32 v205, v119, v199
    v_mul_f32 v207, v135, v199
    v_fmac_f32 v204, v134, v246
    v_fma_f32 v206, -v118, v246, v206
    v_fmac_f32 v205, v135, v247
    v_fma_f32 v207, -v119, v247, v207
    v_cvt_pk_bf16_f32 v37, v204, v205
    v_cvt_pk_bf16_f32 v45, v206, v207
    v_mul_f32 v18, v120, v200
    v_mul_f32 v20, v136, v200
    v_mul_f32 v19, v121, v201
    v_mul_f32 v21, v137, v201
    v_fmac_f32 v18, v136, v248
    v_fma_f32 v20, -v120, v248, v20
    v_fmac_f32 v19, v137, v249
    v_fma_f32 v21, -v121, v249, v21
    v_cvt_pk_bf16_f32 v38, v18, v19
    v_cvt_pk_bf16_f32 v46, v20, v21
    v_mul_f32 v204, v122, v202
    v_mul_f32 v206, v138, v202
    v_mul_f32 v205, v123, v203
    v_mul_f32 v207, v139, v203
    v_fmac_f32 v204, v138, v250
    v_fma_f32 v206, -v122, v250, v206
    v_fmac_f32 v205, v139, v251
    v_fma_f32 v207, -v123, v251, v207
    v_cvt_pk_bf16_f32 v39, v204, v205
    v_cvt_pk_bf16_f32 v47, v206, v207
    v_mfma_f32_32x32x16_bf16 v[108:123], v[32:35], v[212:215], 0
    v_mfma_f32_32x32x16_bf16 v[124:139], v[32:35], v[220:223], 0
    v_mfma_f32_32x32x16_bf16 v[108:123], v[36:39], v[216:219], v[108:123]
    v_mfma_f32_32x32x16_bf16 v[124:139], v[36:39], v[224:227], v[124:139]
    v_mfma_f32_32x32x16_bf16 v[108:123], v[40:43], v[228:231], v[108:123]
    v_mfma_f32_32x32x16_bf16 v[124:139], v[40:43], v[212:215], v[124:139]
    v_mfma_f32_32x32x16_bf16 v[108:123], v[44:47], v[232:235], v[108:123]
    v_mfma_f32_32x32x16_bf16 v[124:139], v[44:47], v[216:219], v[124:139]
    s_nop 10
    v_cvt_pk_bf16_f32 v172, v108, v109
    v_cvt_pk_bf16_f32 v173, v110, v111
    v_cvt_pk_bf16_f32 v174, v112, v113
    v_cvt_pk_bf16_f32 v175, v114, v115
    v_cvt_pk_bf16_f32 v176, v116, v117
    v_cvt_pk_bf16_f32 v177, v118, v119
    v_cvt_pk_bf16_f32 v178, v120, v121
    v_cvt_pk_bf16_f32 v179, v122, v123
    ds_write_b128 v12, v[172:175] offset:0
    ds_write_b128 v13, v[176:179] offset:0
    v_cvt_pk_bf16_f32 v180, v124, v125
    v_cvt_pk_bf16_f32 v181, v126, v127
    v_cvt_pk_bf16_f32 v182, v128, v129
    v_cvt_pk_bf16_f32 v183, v130, v131
    v_cvt_pk_bf16_f32 v184, v132, v133
    v_cvt_pk_bf16_f32 v185, v134, v135
    v_cvt_pk_bf16_f32 v186, v136, v137
    v_cvt_pk_bf16_f32 v187, v138, v139
    ds_write_b128 v12, v[180:183] offset:2064
    ds_write_b128 v13, v[184:187] offset:2064
    ds_read_b128 v[64:67], v14 offset:0
    ds_read_b128 v[68:71], v15 offset:1024
    ds_read_b128 v[72:75], v14 offset:2064
    ds_read_b128 v[76:79], v15 offset:3088
    s_mov_b32 s46, s61
    s_lshl_b32 s46, s46, 6
    s_add_u32 s46, s46, s31
    s_lshl_b32 s46, s46, 12
    s_add_u32 s46, s46, 4194304
    s_waitcnt lgkmcnt(0)
    buffer_store_dwordx4 v[64:67], v27, s[20:23], s46 offen offset:0 sc1
    buffer_store_dwordx4 v[68:71], v27, s[20:23], s46 offen offset:1024 sc1
    buffer_store_dwordx4 v[72:75], v27, s[20:23], s46 offen offset:2048 sc1
    buffer_store_dwordx4 v[76:79], v27, s[20:23], s46 offen offset:3072 sc1
K1_AGAIN:
    s_cmp_eq_u32 s60, 0
    s_cbranch_scc1 K1_TDONE
    s_mov_b32 s60, 0
    s_mov_b32 s61, 16
    s_mul_i32 s46, s51, 4128
    s_sub_u32 s46, 16512, s46
    v_add_u32 v11, s46, v11
    v_add_u32 v12, s46, v12
    v_add_u32 v13, s46, v13
    v_add_u32 v14, s46, v14
    v_add_u32 v15, s46, v15
    s_branch K1_TAIL
K1_TDONE:
K1_END:
    s_endpgm
K1_COMP:
    s_lshr_b32 s46, s34, 2
    s_lshl3_add_u32 s31, s33, s46
    s_and_b32 s32, s34, 3
    v_and_b32 v16, 15, v0
    v_lshrrev_b32 v17, 4, v0
    s_lshl_b32 s46, s28, 9
    v_lshlrev_b32 v18, 4, v16
    v_add_u32 v20, s46, v18
    s_lshl_b32 s47, s31, 11
    v_lshlrev_b32 v19, 18, v17
    v_add3_u32 v21, v20, v19, s47
    s_xor_b32 s52, s32, 0
    s_lshl_b32 s52, s52, 20
    s_xor_b32 s53, s32, 1
    s_lshl_b32 s53, s53, 20
    s_xor_b32 s54, s32, 2
    s_lshl_b32 s54, s54, 20
    s_xor_b32 s55, s32, 3
    s_lshl_b32 s55, s55, 20
    v_add_u32 v18, 131072, v21
    s_waitcnt lgkmcnt(0)
    s_mov_b32 s12, s4
    s_and_b32 s13, s5, 0xffff
    s_mov_b32 s14, 0x400000
    s_mov_b32 s15, 0x00020000
    buffer_load_dwordx4 v[32:35], v21, s[12:15], s52 offen offset:0
    buffer_load_dwordx4 v[36:39], v18, s[12:15], s52 offen offset:0
    buffer_load_dwordx4 v[40:43], v21, s[12:15], s53 offen offset:0
    buffer_load_dwordx4 v[44:47], v18, s[12:15], s53 offen offset:0
    buffer_load_dwordx4 v[48:51], v21, s[12:15], s54 offen offset:0
    buffer_load_dwordx4 v[52:55], v18, s[12:15], s54 offen offset:0
    buffer_load_dwordx4 v[56:59], v21, s[12:15], s55 offen offset:0
    buffer_load_dwordx4 v[60:63], v18, s[12:15], s55 offen offset:0
    s_mov_b32 s24, s8
    s_and_b32 s25, s9, 0xffff
    s_mov_b32 s26, 0x800
    s_mov_b32 s27, 0x00020000
    buffer_load_dwordx4 v[64:67], v21, s[12:15], s52 offen offset:256
    buffer_load_dwordx4 v[68:71], v18, s[12:15], s52 offen offset:256
    buffer_load_dwordx4 v[72:75], v21, s[12:15], s53 offen offset:256
    buffer_load_dwordx4 v[76:79], v18, s[12:15], s53 offen offset:256
    buffer_load_dwordx4 v[80:83], v21, s[12:15], s54 offen offset:256
    buffer_load_dwordx4 v[84:87], v18, s[12:15], s54 offen offset:256
    buffer_load_dwordx4 v[88:91], v21, s[12:15], s55 offen offset:256
    buffer_load_dwordx4 v[92:95], v18, s[12:15], s55 offen offset:256
    buffer_load_dwordx4 v[96:99], v20, s[24:27], 0 offen offset:0
    buffer_load_dwordx4 v[100:103], v20, s[24:27], 0 offen offset:256
    s_and_b32 s33, s28, 1
    s_lshr_b32 s34, s28, 1
    v_and_b32 v10, 15, v0
    v_lshrrev_b32 v11, 4, v0
    s_mul_i32 s35, s33, 72
    s_add_u32 s35, s35, 8
    v_add_u32 v13, s35, v10
    v_bfe_u32 v14, v13, 1, 3
    v_xor_b32 v14, v14, v11
    v_lshlrev_b32 v14, 4, v14
    v_lshl_add_u32 v2, v13, 7, v14
    v_xor_b32 v6, 64, v2
    v_lshrrev_b32 v13, 3, v10
    v_lshl_add_u32 v13, v13, 6, v10
    v_bfe_u32 v14, v13, 1, 3
    v_xor_b32 v14, v14, v11
    v_lshlrev_b32 v14, 4, v14
    v_lshl_add_u32 v3, v13, 7, v14
    v_xor_b32 v7, 64, v3
    v_bfe_u32 v12, v0, 2, 2
    v_lshl_add_u32 v13, v11, 3, v12
    v_lshrrev_b32 v14, 1, v12
    v_and_b32 v15, 1, v11
    v_lshl_or_b32 v14, v15, 1, v14
    v_xor_b32 v14, s28, v14
    v_lshlrev_b32 v14, 5, v14
    v_lshl_add_u32 v14, v13, 7, v14
    v_and_b32 v15, 3, v0
    v_lshl_add_u32 v14, v15, 3, v14
    v_add_u32 v4, 18432, v14
    v_xor_b32 v5, 32, v4
    v_mov_b32 v8, v4
    v_mov_b32 v9, v5
    v_mov_b32 v172, 0
    v_mov_b32 v173, 0
    v_mov_b32 v174, 0
    v_mov_b32 v175, 0
    v_mov_b32 v176, 0
    v_mov_b32 v177, 0
    v_mov_b32 v178, 0
    v_mov_b32 v179, 0
    v_mov_b32 v180, 0
    v_mov_b32 v181, 0
    v_mov_b32 v182, 0
    v_mov_b32 v183, 0
    v_mov_b32 v184, 0
    v_mov_b32 v185, 0
    v_mov_b32 v186, 0
    v_mov_b32 v187, 0
    v_mov_b32 v188, 0
    v_mov_b32 v189, 0
    v_mov_b32 v190, 0
    v_mov_b32 v191, 0
    v_mov_b32 v192, 0
    v_mov_b32 v193, 0
    v_mov_b32 v194, 0
    v_mov_b32 v195, 0
    v_mov_b32 v196, 0
    v_mov_b32 v197, 0
    v_mov_b32 v198, 0
    v_mov_b32 v199, 0
    v_mov_b32 v200, 0
    v_mov_b32 v201, 0
    v_mov_b32 v202, 0
    v_mov_b32 v203, 0
    v_mov_b32 v204, 0
    v_mov_b32 v205, 0
    v_mov_b32 v206, 0
    v_mov_b32 v207, 0
    s_waitcnt lgkmcnt(0)
    s_mov_b32 s20, s10
    s_and_b32 s21, s11, 0xffff
    s_mov_b32 s22, 0xe00000
    s_mov_b32 s23, 0x00020000
    s_mov_b32 s41, 0xf149f2ca
    v_lshlrev_b32 v12, 2, v11
    v_sub_u32 v12, v10, v12
    v_mov_b32 v15, s41
    v_lshrrev_b32 v13, 1, v11
    s_cmp_eq_u32 s29, 0
    s_cselect_b32 s42, 2, s33
    v_cmp_eq_u32 s[44:45], s42, v13
    s_lshl_b32 s43, s33, 3
    v_subrev_u32 v13, 0, v12
    v_cmp_gt_u32 vcc, 8, v13
    s_nop 1
    v_cndmask_b32_e64 v208, v15, 0, vcc
    v_cmp_gt_i32 vcc, -8, v13
    s_nop 1
    v_cndmask_b32_e64 v212, v15, 0, vcc
    v_add_u32 v13, s43, v13
    v_cmp_gt_i32 vcc, 0, v13
    s_nop 0
    s_and_b64 vcc, vcc, s[44:45]
    v_cndmask_b32_e64 v216, v15, 0, vcc
    v_subrev_u32 v13, 1, v12
    v_cmp_gt_u32 vcc, 8, v13
    s_nop 1
    v_cndmask_b32_e64 v209, v15, 0, vcc
    v_cmp_gt_i32 vcc, -8, v13
    s_nop 1
    v_cndmask_b32_e64 v213, v15, 0, vcc
    v_add_u32 v13, s43, v13
    v_cmp_gt_i32 vcc, 0, v13
    s_nop 0
    s_and_b64 vcc, vcc, s[44:45]
    v_cndmask_b32_e64 v217, v15, 0, vcc
    v_subrev_u32 v13, 2, v12
    v_cmp_gt_u32 vcc, 8, v13
    s_nop 1
    v_cndmask_b32_e64 v210, v15, 0, vcc
    v_cmp_gt_i32 vcc, -8, v13
    s_nop 1
    v_cndmask_b32_e64 v214, v15, 0, vcc
    v_add_u32 v13, s43, v13
    v_cmp_gt_i32 vcc, 0, v13
    s_nop 0
    s_and_b64 vcc, vcc, s[44:45]
    v_cndmask_b32_e64 v218, v15, 0, vcc
    v_subrev_u32 v13, 3, v12
    v_cmp_gt_u32 vcc, 8, v13
    s_nop 1
    v_cndmask_b32_e64 v211, v15, 0, vcc
    v_cmp_gt_i32 vcc, -8, v13
    s_nop 1
    v_cndmask_b32_e64 v215, v15, 0, vcc
    v_add_u32 v13, s43, v13
    v_cmp_gt_i32 vcc, 0, v13
    s_nop 0
    s_and_b64 vcc, vcc, s[44:45]
    v_cndmask_b32_e64 v219, v15, 0, vcc
    v_subrev_u32 v13, 0, v12
    v_ashrrev_i32 v14, 31, v13
    v_subrev_u32 v13, 1, v12
    v_ashrrev_i32 v13, 31, v13
    v_and_b32 v14, 0xffff, v14
    v_and_b32 v13, 0xffff0000, v13
    v_or_b32 v220, v13, v14
    v_subrev_u32 v13, 2, v12
    v_ashrrev_i32 v14, 31, v13
    v_subrev_u32 v13, 3, v12
    v_ashrrev_i32 v13, 31, v13
    v_and_b32 v14, 0xffff, v14
    v_and_b32 v13, 0xffff0000, v13
    v_or_b32 v221, v13, v14
    s_lshl_b32 s46, s28, 12
    s_add_u32 s46, s46, 43008
    v_lshlrev_b32 v13, 2, v11
    v_xor_b32 v13, v13, v10
    v_lshlrev_b32 v13, 4, v13
    v_lshl_add_u32 v13, v10, 8, v13
    v_add_u32 v13, s46, v13
    v_add_u32 v223, s43, v13
    v_xor_b32 v224, 8, v223
    v_xor_b32 v13, v10, v11
    v_lshlrev_b32 v13, 4, v13
    v_lshl_add_u32 v13, v11, 8, v13
    v_add_u32 v225, s46, v13
    s_lshl_b32 s46, s33, 17
    s_lshr_b32 s47, s29, 2
    s_lshl_b32 s47, s47, 15
    s_add_u32 s46, s46, s47
    s_lshl1_add_u32 s47, s30, s34
    s_lshl_b32 s47, s47, 10
    s_add_u32 s46, s46, s47
    s_and_b32 s47, s29, 3
    s_lshl_b32 s47, s47, 8
    s_add_u32 s46, s46, s47
    v_lshlrev_b32 v13, 18, v11
    v_lshl_add_u32 v13, v10, 4, v13
    v_add_u32 v222, s46, v13
    s_lshl_b32 s46, s28, 10
    s_add_u32 s46, s46, 59392
    v_lshlrev_b32 v13, 4, v0
    v_add_u32 v226, s46, v13
    v_xor_b32 v227, 1024, v226
    s_lshl_b32 s46, s28, 2
    s_add_u32 s46, s46, 163200
    v_mov_b32 v244, s46
    v_xor_b32 v245, 4, v244
    v_mov_b32 v246, 0
    ds_write_b32 v244, v246
    v_mov_b32 v246, 1
    s_waitcnt lgkmcnt(0)
    v_lshrrev_b32 v18, 1, v16
    s_lshl_b32 s46, s32, 2
    v_add_u32 v18, s46, v18
    v_cmp_gt_u32 vcc, 8, v16
    s_nop 1
    v_cndmask_b32 v18, 16, v18, vcc
    v_cvt_f32_u32 v18, v18
    v_mul_f32 v18, 0x3d000000, v18
    v_and_b32 v19, 1, v16
    v_cvt_f32_u32 v19, v19
    v_mul_f32 v19, 0x3e800000, v19
    v_lshlrev_b32 v20, 1, v17
    s_lshr_b32 s46, s52, 17
    v_add_u32 v21, s46, v20
    v_cvt_f32_u32 v21, v21
    v_fma_f32 v22, v21, v18, v19
    v_add_f32 v23, v22, v18
    v_cos_f32 v22, v22
    v_cos_f32 v23, v23
    s_nop 0
    v_cvt_pk_bf16_f32 v104, v22, v23
    s_lshr_b32 s46, s53, 17
    v_add_u32 v21, s46, v20
    v_cvt_f32_u32 v21, v21
    v_fma_f32 v22, v21, v18, v19
    v_add_f32 v23, v22, v18
    v_cos_f32 v22, v22
    v_cos_f32 v23, v23
    s_nop 0
    v_cvt_pk_bf16_f32 v105, v22, v23
    s_lshr_b32 s46, s54, 17
    v_add_u32 v21, s46, v20
    v_cvt_f32_u32 v21, v21
    v_fma_f32 v22, v21, v18, v19
    v_add_f32 v23, v22, v18
    v_cos_f32 v22, v22
    v_cos_f32 v23, v23
    s_nop 0
    v_cvt_pk_bf16_f32 v106, v22, v23
    s_lshr_b32 s46, s55, 17
    v_add_u32 v21, s46, v20
    v_cvt_f32_u32 v21, v21
    v_fma_f32 v22, v21, v18, v19
    v_add_f32 v23, v22, v18
    v_cos_f32 v22, v22
    v_cos_f32 v23, v23
    s_nop 0
    v_cvt_pk_bf16_f32 v107, v22, v23
    v_mul_u32_u24 v22, 2064, v16
    v_lshl_add_u32 v22, v17, 6, v22
    s_lshl_b32 s46, s28, 9
    s_add_u32 s46, s46, 129024
    v_add_u32 v24, s46, v22
    s_lshl_b32 s46, s28, 5
    s_add_u32 s46, s46, 163072
    v_lshlrev_b32 v25, 3, v17
    v_add_u32 v25, s46, v25
    s_mov_b32 s48, 0x05040100
    s_mov_b32 s49, 0x07060302
    s_waitcnt vmcnt(10)
    v_perm_b32 v108, v36, v32, s48
    v_perm_b32 v112, v36, v32, s49
    v_perm_b32 v109, v44, v40, s48
    v_perm_b32 v113, v44, v40, s49
    v_perm_b32 v110, v52, v48, s48
    v_perm_b32 v114, v52, v48, s49
    v_perm_b32 v111, v60, v56, s48
    v_perm_b32 v115, v60, v56, s49
    v_perm_b32 v116, v37, v33, s48
    v_perm_b32 v120, v37, v33, s49
    v_perm_b32 v117, v45, v41, s48
    v_perm_b32 v121, v45, v41, s49
    v_perm_b32 v118, v53, v49, s48
    v_perm_b32 v122, v53, v49, s49
    v_perm_b32 v119, v61, v57, s48
    v_perm_b32 v123, v61, v57, s49
    v_mfma_f32_16x16x32_bf16 v[140:143], v[108:111], v[104:107], 0
    v_mfma_f32_16x16x32_bf16 v[144:147], v[112:115], v[104:107], 0
    v_perm_b32 v124, v38, v34, s48
    v_perm_b32 v128, v38, v34, s49
    v_perm_b32 v125, v46, v42, s48
    v_perm_b32 v129, v46, v42, s49
    v_perm_b32 v126, v54, v50, s48
    v_perm_b32 v130, v54, v50, s49
    v_perm_b32 v127, v62, v58, s48
    v_perm_b32 v131, v62, v58, s49
    v_mfma_f32_16x16x32_bf16 v[148:151], v[116:119], v[104:107], 0
    v_mfma_f32_16x16x32_bf16 v[152:155], v[120:123], v[104:107], 0
    v_perm_b32 v132, v39, v35, s48
    v_perm_b32 v136, v39, v35, s49
    v_perm_b32 v133, v47, v43, s48
    v_perm_b32 v137, v47, v43, s49
    v_perm_b32 v134, v55, v51, s48
    v_perm_b32 v138, v55, v51, s49
    v_perm_b32 v135, v63, v59, s48
    v_perm_b32 v139, v63, v59, s49
    v_mfma_f32_16x16x32_bf16 v[156:159], v[124:127], v[104:107], 0
    v_mfma_f32_16x16x32_bf16 v[160:163], v[128:131], v[104:107], 0
    v_mfma_f32_16x16x32_bf16 v[164:167], v[132:135], v[104:107], 0
    v_mfma_f32_16x16x32_bf16 v[168:171], v[136:139], v[104:107], 0
    v_cvt_pk_bf16_f32 v48, v140, v144
    v_cvt_pk_bf16_f32 v49, v148, v152
    s_nop 3
    v_cvt_pk_bf16_f32 v50, v156, v160
    s_nop 0
    v_cvt_pk_bf16_f32 v51, v164, v168
    ds_write_b128 v24, v[48:51] offset:0
    v_cvt_pk_bf16_f32 v52, v141, v145
    v_cvt_pk_bf16_f32 v53, v149, v153
    v_cvt_pk_bf16_f32 v54, v157, v161
    v_cvt_pk_bf16_f32 v55, v165, v169
    ds_write_b128 v24, v[52:55] offset:16
    v_cvt_pk_bf16_f32 v56, v142, v146
    v_cvt_pk_bf16_f32 v57, v150, v154
    v_cvt_pk_bf16_f32 v58, v158, v162
    v_cvt_pk_bf16_f32 v59, v166, v170
    ds_write_b128 v24, v[56:59] offset:32
    v_cvt_pk_bf16_f32 v60, v143, v147
    v_cvt_pk_bf16_f32 v61, v151, v155
    v_cvt_pk_bf16_f32 v62, v159, v163
    v_cvt_pk_bf16_f32 v63, v167, v171
    ds_write_b128 v24, v[60:63] offset:48
    s_waitcnt vmcnt(2)
    v_perm_b32 v108, v68, v64, s48
    v_perm_b32 v112, v68, v64, s49
    v_perm_b32 v109, v76, v72, s48
    v_perm_b32 v113, v76, v72, s49
    v_perm_b32 v110, v84, v80, s48
    v_perm_b32 v114, v84, v80, s49
    v_perm_b32 v111, v92, v88, s48
    v_perm_b32 v115, v92, v88, s49
    v_perm_b32 v116, v69, v65, s48
    v_perm_b32 v120, v69, v65, s49
    v_perm_b32 v117, v77, v73, s48
    v_perm_b32 v121, v77, v73, s49
    v_perm_b32 v118, v85, v81, s48
    v_perm_b32 v122, v85, v81, s49
    v_perm_b32 v119, v93, v89, s48
    v_perm_b32 v123, v93, v89, s49
    v_mfma_f32_16x16x32_bf16 v[140:143], v[108:111], v[104:107], 0
    v_mfma_f32_16x16x32_bf16 v[144:147], v[112:115], v[104:107], 0
    v_perm_b32 v124, v70, v66, s48
    v_perm_b32 v128, v70, v66, s49
    v_perm_b32 v125, v78, v74, s48
    v_perm_b32 v129, v78, v74, s49
    v_perm_b32 v126, v86, v82, s48
    v_perm_b32 v130, v86, v82, s49
    v_perm_b32 v127, v94, v90, s48
    v_perm_b32 v131, v94, v90, s49
    v_mfma_f32_16x16x32_bf16 v[148:151], v[116:119], v[104:107], 0
    v_mfma_f32_16x16x32_bf16 v[152:155], v[120:123], v[104:107], 0
    v_perm_b32 v132, v71, v67, s48
    v_perm_b32 v136, v71, v67, s49
    v_perm_b32 v133, v79, v75, s48
    v_perm_b32 v137, v79, v75, s49
    v_perm_b32 v134, v87, v83, s48
    v_perm_b32 v138, v87, v83, s49
    v_perm_b32 v135, v95, v91, s48
    v_perm_b32 v139, v95, v91, s49
    v_mfma_f32_16x16x32_bf16 v[156:159], v[124:127], v[104:107], 0
    v_mfma_f32_16x16x32_bf16 v[160:163], v[128:131], v[104:107], 0
    v_mfma_f32_16x16x32_bf16 v[164:167], v[132:135], v[104:107], 0
    v_mfma_f32_16x16x32_bf16 v[168:171], v[136:139], v[104:107], 0
    s_waitcnt vmcnt(0)
    v_mov_b32 v28, 0
    v_mov_b32 v29, 0
    v_dot2c_f32_bf16 v28, v32, v96
    v_dot2c_f32_bf16 v29, v36, v96
    v_dot2c_f32_bf16 v28, v33, v97
    v_dot2c_f32_bf16 v29, v37, v97
    v_dot2c_f32_bf16 v28, v34, v98
    v_dot2c_f32_bf16 v29, v38, v98
    v_dot2c_f32_bf16 v28, v35, v99
    v_dot2c_f32_bf16 v29, v39, v99
    v_dot2c_f32_bf16 v28, v64, v100
    v_dot2c_f32_bf16 v29, v68, v100
    v_dot2c_f32_bf16 v28, v65, v101
    v_dot2c_f32_bf16 v29, v69, v101
    v_dot2c_f32_bf16 v28, v66, v102
    v_dot2c_f32_bf16 v29, v70, v102
    v_dot2c_f32_bf16 v28, v67, v103
    v_dot2c_f32_bf16 v29, v71, v103
    v_cvt_pk_bf16_f32 v80, v140, v144
    v_cvt_pk_bf16_f32 v81, v148, v152
    v_cvt_pk_bf16_f32 v82, v156, v160
    v_cvt_pk_bf16_f32 v83, v164, v168
    ds_write_b128 v24, v[80:83] offset:256
    v_cvt_pk_bf16_f32 v84, v141, v145
    v_cvt_pk_bf16_f32 v85, v149, v153
    v_cvt_pk_bf16_f32 v86, v157, v161
    v_cvt_pk_bf16_f32 v87, v165, v169
    ds_write_b128 v24, v[84:87] offset:272
    v_cvt_pk_bf16_f32 v88, v142, v146
    v_cvt_pk_bf16_f32 v89, v150, v154
    v_cvt_pk_bf16_f32 v90, v158, v162
    v_cvt_pk_bf16_f32 v91, v166, v170
    ds_write_b128 v24, v[88:91] offset:288
    v_cvt_pk_bf16_f32 v92, v143, v147
    v_cvt_pk_bf16_f32 v93, v151, v155
    v_cvt_pk_bf16_f32 v94, v159, v163
    v_cvt_pk_bf16_f32 v95, v167, v171
    ds_write_b128 v24, v[92:95] offset:304
    v_add_f32_dpp v28, v28, v28 row_ror:8 row_mask:0xf bank_mask:0xf
    v_mov_b32 v104, 0
    v_mov_b32 v105, 0
    v_add_f32_dpp v29, v29, v29 row_ror:8 row_mask:0xf bank_mask:0xf
    v_mov_b32 v106, 0
    v_mov_b32 v107, 0
    v_add_f32_dpp v28, v28, v28 row_ror:4 row_mask:0xf bank_mask:0xf
    v_mov_b32 v108, 0
    v_mov_b32 v109, 0
    v_add_f32_dpp v29, v29, v29 row_ror:4 row_mask:0xf bank_mask:0xf
    v_mov_b32 v110, 0
    v_mov_b32 v111, 0
    v_add_f32_dpp v28, v28, v28 row_ror:2 row_mask:0xf bank_mask:0xf
    v_mov_b32 v112, 0
    v_mov_b32 v113, 0
    v_add_f32_dpp v29, v29, v29 row_ror:2 row_mask:0xf bank_mask:0xf
    v_mov_b32 v114, 0
    v_mov_b32 v115, 0
    v_add_f32_dpp v28, v28, v28 row_ror:1 row_mask:0xf bank_mask:0xf
    v_mov_b32 v116, 0
    v_mov_b32 v117, 0
    v_add_f32_dpp v29, v29, v29 row_ror:1 row_mask:0xf bank_mask:0xf
    v_mov_b32 v118, 0
    v_mov_b32 v119, 0
    ds_write_b64 v25, v[28:29]
    v_mov_b32 v120, 0
    v_mov_b32 v121, 0
    v_mov_b32 v122, 0
    v_mov_b32 v123, 0
    v_mov_b32 v124, 0
    v_mov_b32 v125, 0
    v_mov_b32 v126, 0
    v_mov_b32 v127, 0
    v_mov_b32 v128, 0
    v_mov_b32 v129, 0
    v_mov_b32 v130, 0
    v_mov_b32 v131, 0
    v_mov_b32 v132, 0
    v_mov_b32 v133, 0
    v_mov_b32 v134, 0
    v_mov_b32 v135, 0
    v_mov_b32 v136, 0
    v_mov_b32 v137, 0
    v_mov_b32 v138, 0
    v_mov_b32 v139, 0
    v_mov_b32 v140, 0
    v_mov_b32 v141, 0
    v_mov_b32 v142, 0
    v_mov_b32 v143, 0
    v_mov_b32 v144, 0
    v_mov_b32 v145, 0
    v_mov_b32 v146, 0
    v_mov_b32 v147, 0
    v_mov_b32 v148, 0
    v_mov_b32 v149, 0
    v_mov_b32 v150, 0
    v_mov_b32 v151, 0
    v_mov_b32 v152, 0
    v_mov_b32 v153, 0
    v_mov_b32 v154, 0
    v_mov_b32 v155, 0
    v_mov_b32 v156, 0
    v_mov_b32 v157, 0
    v_mov_b32 v158, 0
    v_mov_b32 v159, 0
    v_mov_b32 v160, 0
    v_mov_b32 v161, 0
    v_mov_b32 v162, 0
    v_mov_b32 v163, 0
    v_mov_b32 v164, 0
    v_mov_b32 v165, 0
    v_mov_b32 v166, 0
    v_mov_b32 v167, 0
    v_mov_b32 v168, 0
    v_mov_b32 v169, 0
    v_mov_b32 v170, 0
    v_mov_b32 v171, 0
    s_waitcnt lgkmcnt(0)
    s_mov_b32 s36, 0
    s_mov_b32 s37, 0
    s_mov_b32 s39, 43008
    s_mov_b32 s40, 4294881280
    s_barrier
    ds_read_b64_tr_b16 v[64:65], v4 offset:8192
    ds_read_b64_tr_b16 v[66:67], v4 offset:8704
    ds_read_b128 v[16:19], v3
    ds_read_b128 v[20:23], v2 offset:0
    ds_read_b128 v[24:27], v2 offset:2048
    ds_read_b128 v[28:31], v2 offset:4096
    ds_read_b128 v[32:35], v2 offset:6144
    ds_read_b64_tr_b16 v[68:69], v5 offset:8192
    ds_read_b64_tr_b16 v[70:71], v5 offset:8704
    ds_read_b64_tr_b16 v[72:73], v4 offset:16384
    ds_read_b64_tr_b16 v[74:75], v4 offset:16896
    ds_read_b64_tr_b16 v[76:77], v5 offset:16384
    ds_read_b64_tr_b16 v[78:79], v5 offset:16896
    ds_read_b64_tr_b16 v[56:57], v4 offset:0
    ds_read_b64_tr_b16 v[58:59], v4 offset:512
    ds_read_b64_tr_b16 v[60:61], v5 offset:0
    ds_read_b64_tr_b16 v[62:63], v5 offset:512
K1_LOOP:
    s_waitcnt lgkmcnt(0)
    v_mfma_f32_16x16x32_bf16 v[200:203], v[64:67], v[16:19], v[200:203]
    ds_read_b64_tr_b16 v[88:89], v8 offset:12288
    s_add_u32 s37, s37, 1
    v_mfma_f32_16x16x32_bf16 v[136:139], v[64:67], v[20:23], v[136:139]
    ds_read_b64_tr_b16 v[90:91], v8 offset:12800
    s_cmp_eq_u32 s37, 3
    v_mfma_f32_16x16x32_bf16 v[144:147], v[64:67], v[24:27], v[144:147]
    ds_read_b128 v[36:39], v7
    s_cselect_b32 s38, s40, s39
    v_mfma_f32_16x16x32_bf16 v[152:155], v[64:67], v[28:31], v[152:155]
    ds_read_b128 v[40:43], v6 offset:0
    s_cselect_b32 s37, 0, s37
    v_mfma_f32_16x16x32_bf16 v[160:163], v[64:67], v[32:35], v[160:163]
    ds_read_b128 v[44:47], v6 offset:2048
    v_mfma_f32_16x16x32_bf16 v[140:143], v[68:71], v[20:23], v[140:143]
    ds_read_b128 v[48:51], v6 offset:4096
    v_mfma_f32_16x16x32_bf16 v[148:151], v[68:71], v[24:27], v[148:151]
    ds_read_b128 v[52:55], v6 offset:6144
    v_mfma_f32_16x16x32_bf16 v[156:159], v[68:71], v[28:31], v[156:159]
    ds_read_b64_tr_b16 v[92:93], v9 offset:12288
    v_mfma_f32_16x16x32_bf16 v[164:167], v[68:71], v[32:35], v[164:167]
    ds_read_b64_tr_b16 v[94:95], v9 offset:12800
    v_mfma_f32_16x16x32_bf16 v[204:207], v[16:19], v[72:75], v[204:207]
    ds_read_b64_tr_b16 v[96:97], v8 offset:20480
    v_mfma_f32_16x16x32_bf16 v[168:171], v[20:23], v[72:75], v[168:171]
    ds_read_b64_tr_b16 v[98:99], v8 offset:20992
    v_mfma_f32_16x16x32_bf16 v[176:179], v[24:27], v[72:75], v[176:179]
    ds_read_b64_tr_b16 v[100:101], v9 offset:20480
    v_mfma_f32_16x16x32_bf16 v[184:187], v[28:31], v[72:75], v[184:187]
    ds_read_b64_tr_b16 v[102:103], v9 offset:20992
    v_mfma_f32_16x16x32_bf16 v[192:195], v[32:35], v[72:75], v[192:195]
    ds_read_b64_tr_b16 v[80:81], v8 offset:4096
    v_mfma_f32_16x16x32_bf16 v[172:175], v[20:23], v[76:79], v[172:175]
    ds_read_b64_tr_b16 v[82:83], v8 offset:4608
    v_mfma_f32_16x16x32_bf16 v[180:183], v[24:27], v[76:79], v[180:183]
    ds_read_b64_tr_b16 v[84:85], v9 offset:4096
    v_mfma_f32_16x16x32_bf16 v[188:191], v[28:31], v[76:79], v[188:191]
    ds_read_b64_tr_b16 v[86:87], v9 offset:4608
    v_mfma_f32_16x16x32_bf16 v[196:199], v[32:35], v[76:79], v[196:199]
    v_add_u32 v2, s38, v2
    v_mfma_f32_16x16x32_bf16 v[104:107], v[56:59], v[20:23], v[104:107]
    v_add_u32 v3, s38, v3
    v_mfma_f32_16x16x32_bf16 v[112:115], v[56:59], v[24:27], v[112:115]
    v_add_u32 v4, s38, v4
    v_mfma_f32_16x16x32_bf16 v[120:123], v[56:59], v[28:31], v[120:123]
    v_add_u32 v5, s38, v5
    v_mfma_f32_16x16x32_bf16 v[128:131], v[56:59], v[32:35], v[128:131]
    s_cmp_ge_u32 s36, 14
    v_mfma_f32_16x16x32_bf16 v[108:111], v[60:63], v[20:23], v[108:111]
    s_waitcnt lgkmcnt(0)
    s_cbranch_scc1 K1_LAST
    s_barrier
K1_NOBAR:
    v_mfma_f32_16x16x32_bf16 v[116:119], v[60:63], v[24:27], v[116:119]
    v_mfma_f32_16x16x32_bf16 v[124:127], v[60:63], v[28:31], v[124:127]
    v_mfma_f32_16x16x32_bf16 v[132:135], v[60:63], v[32:35], v[132:135]
    v_mfma_f32_16x16x32_bf16 v[200:203], v[88:91], v[36:39], v[200:203]
    ds_read_b64_tr_b16 v[64:65], v4 offset:8192
    v_mfma_f32_16x16x32_bf16 v[136:139], v[88:91], v[40:43], v[136:139]
    ds_read_b64_tr_b16 v[66:67], v4 offset:8704
    v_mfma_f32_16x16x32_bf16 v[144:147], v[88:91], v[44:47], v[144:147]
    ds_read_b128 v[16:19], v3
    v_mfma_f32_16x16x32_bf16 v[152:155], v[88:91], v[48:51], v[152:155]
    ds_read_b128 v[20:23], v2 offset:0
    v_mfma_f32_16x16x32_bf16 v[160:163], v[88:91], v[52:55], v[160:163]
    ds_read_b128 v[24:27], v2 offset:2048
    v_mfma_f32_16x16x32_bf16 v[140:143], v[92:95], v[40:43], v[140:143]
    ds_read_b128 v[28:31], v2 offset:4096
    v_mfma_f32_16x16x32_bf16 v[148:151], v[92:95], v[44:47], v[148:151]
    ds_read_b128 v[32:35], v2 offset:6144
    v_mfma_f32_16x16x32_bf16 v[156:159], v[92:95], v[48:51], v[156:159]
    ds_read_b64_tr_b16 v[68:69], v5 offset:8192
    v_mfma_f32_16x16x32_bf16 v[164:167], v[92:95], v[52:55], v[164:167]
    ds_read_b64_tr_b16 v[70:71], v5 offset:8704
    v_mfma_f32_16x16x32_bf16 v[204:207], v[36:39], v[96:99], v[204:207]
    ds_read_b64_tr_b16 v[72:73], v4 offset:16384
    v_mfma_f32_16x16x32_bf16 v[168:171], v[40:43], v[96:99], v[168:171]
    ds_read_b64_tr_b16 v[74:75], v4 offset:16896
    v_mfma_f32_16x16x32_bf16 v[176:179], v[44:47], v[96:99], v[176:179]
    ds_read_b64_tr_b16 v[76:77], v5 offset:16384
    v_mfma_f32_16x16x32_bf16 v[184:187], v[48:51], v[96:99], v[184:187]
    ds_read_b64_tr_b16 v[78:79], v5 offset:16896
    v_mfma_f32_16x16x32_bf16 v[192:195], v[52:55], v[96:99], v[192:195]
    ds_read_b64_tr_b16 v[56:57], v4 offset:0
    v_mfma_f32_16x16x32_bf16 v[172:175], v[40:43], v[100:103], v[172:175]
    ds_read_b64_tr_b16 v[58:59], v4 offset:512
    v_mfma_f32_16x16x32_bf16 v[180:183], v[44:47], v[100:103], v[180:183]
    ds_read_b64_tr_b16 v[60:61], v5 offset:0
    v_mfma_f32_16x16x32_bf16 v[188:191], v[48:51], v[100:103], v[188:191]
    ds_read_b64_tr_b16 v[62:63], v5 offset:512
    v_mfma_f32_16x16x32_bf16 v[196:199], v[52:55], v[100:103], v[196:199]
    v_add_u32 v6, s38, v6
    v_mfma_f32_16x16x32_bf16 v[104:107], v[80:83], v[40:43], v[104:107]
    v_add_u32 v7, s38, v7
    v_mfma_f32_16x16x32_bf16 v[112:115], v[80:83], v[44:47], v[112:115]
    v_add_u32 v8, s38, v8
    v_mfma_f32_16x16x32_bf16 v[120:123], v[80:83], v[48:51], v[120:123]
    v_add_u32 v9, s38, v9
    v_mfma_f32_16x16x32_bf16 v[128:131], v[80:83], v[52:55], v[128:131]
    s_add_u32 s36, s36, 1
    v_mfma_f32_16x16x32_bf16 v[108:111], v[84:87], v[40:43], v[108:111]
    s_cmp_lt_u32 s36, 16
    v_mfma_f32_16x16x32_bf16 v[116:119], v[84:87], v[44:47], v[116:119]
    v_mfma_f32_16x16x32_bf16 v[124:127], v[84:87], v[48:51], v[124:127]
    v_mfma_f32_16x16x32_bf16 v[132:135], v[84:87], v[52:55], v[132:135]
    s_cbranch_scc1 K1_LOOP
    s_waitcnt lgkmcnt(0)
    v_cvt_pk_bf16_f32 v72, v200, v201
    v_cvt_pk_bf16_f32 v73, v202, v203
    v_cvt_pk_bf16_f32 v74, v204, v205
    v_cvt_pk_bf16_f32 v75, v206, v207
    ds_write_b128 v226, v[72:75]
    ds_write_b32 v244, v246
    v_cvt_pk_bf16_f32 v36, v136, v137
    v_cvt_pk_bf16_f32 v37, v138, v139
    v_cvt_pk_bf16_f32 v38, v140, v141
    v_cvt_pk_bf16_f32 v39, v142, v143
    v_cvt_pk_bf16_f32 v40, v144, v145
    v_cvt_pk_bf16_f32 v41, v146, v147
    v_cvt_pk_bf16_f32 v42, v148, v149
    v_cvt_pk_bf16_f32 v43, v150, v151
    v_cvt_pk_bf16_f32 v44, v152, v153
    v_cvt_pk_bf16_f32 v45, v154, v155
    v_cvt_pk_bf16_f32 v46, v156, v157
    v_cvt_pk_bf16_f32 v47, v158, v159
    v_cvt_pk_bf16_f32 v48, v160, v161
    v_cvt_pk_bf16_f32 v49, v162, v163
    v_cvt_pk_bf16_f32 v50, v164, v165
    v_cvt_pk_bf16_f32 v51, v166, v167
    v_mov_b32 v32, v72
    v_mov_b32 v33, v73
    v_mov_b32 v52, v74
    v_mov_b32 v53, v75
    v_cvt_pk_bf16_f32 v28, v128, v129
    v_cvt_pk_bf16_f32 v29, v130, v131
    v_cvt_pk_bf16_f32 v30, v132, v133
    v_cvt_pk_bf16_f32 v31, v134, v135
    v_cvt_pk_bf16_f32 v24, v120, v121
    v_cvt_pk_bf16_f32 v25, v122, v123
    v_cvt_pk_bf16_f32 v26, v124, v125
    v_cvt_pk_bf16_f32 v27, v126, v127
    v_mfma_f32_16x16x32_bf16 v[240:243], v[48:51], v[28:31], v[208:211]
    v_mfma_f32_16x16x32_bf16 v[92:95], v[44:47], v[28:31], v[212:215]
    v_cvt_pk_bf16_f32 v20, v112, v113
    v_cvt_pk_bf16_f32 v21, v114, v115
    v_cvt_pk_bf16_f32 v22, v116, v117
    v_cvt_pk_bf16_f32 v23, v118, v119
    v_mfma_f32_16x16x32_bf16 v[236:239], v[44:47], v[24:27], v[208:211]
    v_mfma_f32_16x16x32_bf16 v[88:91], v[40:43], v[24:27], v[212:215]
    v_cvt_pk_bf16_f32 v16, v104, v105
    v_cvt_pk_bf16_f32 v17, v106, v107
    v_cvt_pk_bf16_f32 v18, v108, v109
    v_cvt_pk_bf16_f32 v19, v110, v111
    v_mfma_f32_16x16x32_bf16 v[232:235], v[40:43], v[20:23], v[208:211]
    v_mfma_f32_16x16x32_bf16 v[84:87], v[36:39], v[20:23], v[212:215]
    ds_read_b32 v247, v245
    ds_read_b128 v[76:79], v227
    v_mfma_f32_16x16x32_bf16 v[228:231], v[36:39], v[16:19], v[208:211]
    v_max_f32 v240, v240, v92
    v_max_f32 v241, v241, v93
    v_max_f32 v242, v242, v94
    v_max_f32 v243, v243, v95
    v_cvt_pk_bf16_f32 v240, 0, v240
    v_cvt_pk_bf16_f32 v241, 0, v241
    v_cvt_pk_bf16_f32 v242, 0, v242
    v_cvt_pk_bf16_f32 v243, 0, v243
    v_mul_f32 v240, 0x3e3504f3, v240
    v_mul_f32 v241, 0x3e3504f3, v241
    v_mul_f32 v242, 0x3e3504f3, v242
    v_mul_f32 v243, 0x3e3504f3, v243
    v_cvt_pk_bf16_f32 v240, 0, v240
    v_cvt_pk_bf16_f32 v241, 0, v241
    v_cvt_pk_bf16_f32 v242, 0, v242
    v_cvt_pk_bf16_f32 v243, 0, v243
    v_max3_f32 v99, v240, v241, v242
    v_max_f32 v99, v99, v243
    v_max_f32 v236, v236, v88
    v_max_f32 v237, v237, v89
    v_max_f32 v238, v238, v90
    v_max_f32 v239, v239, v91
    v_cvt_pk_bf16_f32 v236, 0, v236
    v_cvt_pk_bf16_f32 v237, 0, v237
    v_cvt_pk_bf16_f32 v238, 0, v238
    v_cvt_pk_bf16_f32 v239, 0, v239
    v_mul_f32 v236, 0x3e3504f3, v236
    v_mul_f32 v237, 0x3e3504f3, v237
    v_mul_f32 v238, 0x3e3504f3, v238
    v_mul_f32 v239, 0x3e3504f3, v239
    v_cvt_pk_bf16_f32 v236, 0, v236
    v_cvt_pk_bf16_f32 v237, 0, v237
    v_cvt_pk_bf16_f32 v238, 0, v238
    v_cvt_pk_bf16_f32 v239, 0, v239
    v_max3_f32 v98, v236, v237, v238
    v_max_f32 v98, v98, v239
    s_branch K1_POLL2
K1_POLL:
    ds_read_b32 v247, v245
    ds_read_b128 v[76:79], v227
K1_POLL2:
    s_waitcnt lgkmcnt(0)
    v_readfirstlane_b32 s46, v247
    v_mov_b32 v34, v76
    s_cmp_eq_u32 s46, 1
    s_cbranch_scc0 K1_POLL
    v_mov_b32 v35, v77
    v_mov_b32 v62, v78
    v_mov_b32 v63, v79
    v_mfma_f32_16x16x32_bf16 v[80:83], v[32:35], v[16:19], v[216:219]
    v_max_f32 v232, v232, v84
    v_max_f32 v233, v233, v85
    v_max_f32 v234, v234, v86
    v_max_f32 v235, v235, v87
    v_cvt_pk_bf16_f32 v232, 0, v232
    v_cvt_pk_bf16_f32 v233, 0, v233
    v_cvt_pk_bf16_f32 v234, 0, v234
    v_cvt_pk_bf16_f32 v235, 0, v235
    v_mul_f32 v232, 0x3e3504f3, v232
    v_mul_f32 v233, 0x3e3504f3, v233
    v_mul_f32 v234, 0x3e3504f3, v234
    v_mul_f32 v235, 0x3e3504f3, v235
    v_cvt_pk_bf16_f32 v232, 0, v232
    v_cvt_pk_bf16_f32 v233, 0, v233
    v_cvt_pk_bf16_f32 v234, 0, v234
    v_cvt_pk_bf16_f32 v235, 0, v235
    v_max3_f32 v97, v232, v233, v234
    v_max_f32 v97, v97, v235
    v_cvt_pk_bf16_f32 v54, v168, v169
    v_cvt_pk_bf16_f32 v55, v170, v171
    v_max_f32 v228, v228, v80
    v_max_f32 v229, v229, v81
    v_max_f32 v230, v230, v82
    v_max_f32 v231, v231, v83
    v_cvt_pk_bf16_f32 v228, 0, v228
    v_cvt_pk_bf16_f32 v229, 0, v229
    v_cvt_pk_bf16_f32 v230, 0, v230
    v_cvt_pk_bf16_f32 v231, 0, v231
    v_mul_f32 v228, 0x3e3504f3, v228
    v_mul_f32 v229, 0x3e3504f3, v229
    v_mul_f32 v230, 0x3e3504f3, v230
    v_mul_f32 v231, 0x3e3504f3, v231
    v_cvt_pk_bf16_f32 v228, 0, v228
    v_cvt_pk_bf16_f32 v229, 0, v229
    v_cvt_pk_bf16_f32 v230, 0, v230
    v_cvt_pk_bf16_f32 v231, 0, v231
    v_max3_f32 v96, v228, v229, v230
    v_max_f32 v96, v96, v231
    s_mov_b32 s45, 0x3fb8aa3b
    v_permlane16_swap_b32 v98, v99
    v_cvt_pk_bf16_f32 v56, v176, v177
    v_permlane16_swap_b32 v96, v97
    v_max_f32 v98, v98, v99
    v_max_f32 v96, v96, v97
    v_cvt_pk_bf16_f32 v57, v178, v179
    v_cvt_pk_bf16_f32 v58, v184, v185
    v_permlane32_swap_b32 v96, v98
    v_max_f32 v96, v96, v98
    v_mul_f32 v96, 0xbfb8aa3b, v96
    v_cvt_pk_bf16_f32 v59, v186, v187
    v_mov_b32 v98, v96
    v_cvt_pk_bf16_f32 v60, v192, v193
    v_cvt_pk_bf16_f32 v61, v194, v195
    v_permlane32_swap_b32 v96, v98
    v_mov_b32 v97, v96
    v_mov_b32 v99, v98
    v_cvt_pk_bf16_f32 v64, v172, v173
    v_permlane16_swap_b32 v96, v97
    v_permlane16_swap_b32 v98, v99
    v_fma_f32 v228, v228, s45, v96
    v_fma_f32 v229, v229, s45, v96
    v_fma_f32 v230, v230, s45, v96
    v_fma_f32 v231, v231, s45, v96
    v_exp_f32 v228, v228
    v_exp_f32 v229, v229
    v_exp_f32 v230, v230
    v_exp_f32 v231, v231
    v_fma_f32 v232, v232, s45, v97
    v_fma_f32 v233, v233, s45, v97
    v_fma_f32 v234, v234, s45, v97
    v_fma_f32 v235, v235, s45, v97
    v_exp_f32 v232, v232
    v_exp_f32 v233, v233
    v_exp_f32 v234, v234
    v_exp_f32 v235, v235
    v_fma_f32 v236, v236, s45, v98
    v_fma_f32 v237, v237, s45, v98
    v_fma_f32 v238, v238, s45, v98
    v_fma_f32 v239, v239, s45, v98
    v_exp_f32 v236, v236
    v_exp_f32 v237, v237
    v_exp_f32 v238, v238
    v_exp_f32 v239, v239
    v_fma_f32 v240, v240, s45, v99
    v_fma_f32 v241, v241, s45, v99
    v_fma_f32 v242, v242, s45, v99
    v_fma_f32 v243, v243, s45, v99
    v_exp_f32 v240, v240
    v_exp_f32 v241, v241
    v_exp_f32 v242, v242
    v_exp_f32 v243, v243
    v_add_f32 v98, v236, v237
    v_add_f32 v88, v238, v239
    v_add_f32 v98, v98, v88
    v_add_f32 v99, v240, v241
    v_add_f32 v92, v242, v243
    v_add_f32 v99, v99, v92
    v_add_f32 v96, v228, v229
    v_add_f32 v80, v230, v231
    v_add_f32 v96, v96, v80
    v_add_f32 v97, v232, v233
    v_add_f32 v84, v234, v235
    v_add_f32 v97, v97, v84
    v_permlane16_swap_b32 v98, v99
    v_cvt_pk_bf16_f32 v65, v174, v175
    v_permlane16_swap_b32 v96, v97
    v_add_f32 v98, v98, v99
    v_add_f32 v96, v96, v97
    v_cvt_pk_bf16_f32 v66, v180, v181
    v_cvt_pk_bf16_f32 v67, v182, v183
    v_permlane32_swap_b32 v96, v98
    v_add_f32 v96, v96, v98
    v_rcp_f32 v96, v96
    v_cvt_pk_bf16_f32 v68, v188, v189
    v_mov_b32 v98, v96
    v_cvt_pk_bf16_f32 v69, v190, v191
    v_cvt_pk_bf16_f32 v70, v196, v197
    v_permlane32_swap_b32 v96, v98
    v_mov_b32 v97, v96
    v_mov_b32 v99, v98
    v_cvt_pk_bf16_f32 v71, v198, v199
    v_permlane16_swap_b32 v96, v97
    v_permlane16_swap_b32 v98, v99
    v_mul_f32 v228, v228, v96
    v_mul_f32 v229, v229, v96
    v_mul_f32 v230, v230, v96
    v_mul_f32 v231, v231, v96
    v_cvt_pk_bf16_f32 v228, v228, v229
    v_cvt_pk_bf16_f32 v229, v230, v231
    v_and_b32 v80, v220, v228
    v_and_b32 v81, v221, v229
    v_bfi_b32 v82, v220, 0, v228
    v_bfi_b32 v83, v221, 0, v229
    v_mul_f32 v232, v232, v97
    v_mul_f32 v233, v233, v97
    v_mul_f32 v234, v234, v97
    v_mul_f32 v235, v235, v97
    v_cvt_pk_bf16_f32 v232, v232, v233
    v_cvt_pk_bf16_f32 v233, v234, v235
    v_and_b32 v84, v220, v232
    v_and_b32 v85, v221, v233
    v_bfi_b32 v86, v220, 0, v232
    v_bfi_b32 v87, v221, 0, v233
    v_mfma_f32_16x16x32_bf16 v[104:107], v[52:55], v[80:83], 0
    v_mfma_f32_16x16x32_bf16 v[108:111], v[62:65], v[80:83], 0
    v_mul_f32 v236, v236, v98
    v_mul_f32 v237, v237, v98
    v_mul_f32 v238, v238, v98
    v_mul_f32 v239, v239, v98
    v_cvt_pk_bf16_f32 v236, v236, v237
    v_cvt_pk_bf16_f32 v237, v238, v239
    v_and_b32 v88, v220, v236
    v_and_b32 v89, v221, v237
    v_bfi_b32 v90, v220, 0, v236
    v_bfi_b32 v91, v221, 0, v237
    v_mfma_f32_16x16x32_bf16 v[112:115], v[54:57], v[84:87], 0
    v_mfma_f32_16x16x32_bf16 v[116:119], v[64:67], v[84:87], 0
    v_mul_f32 v240, v240, v99
    v_mul_f32 v241, v241, v99
    v_mul_f32 v242, v242, v99
    v_mul_f32 v243, v243, v99
    v_cvt_pk_bf16_f32 v240, v240, v241
    v_cvt_pk_bf16_f32 v241, v242, v243
    v_and_b32 v92, v220, v240
    v_and_b32 v93, v221, v241
    v_bfi_b32 v94, v220, 0, v240
    v_bfi_b32 v95, v221, 0, v241
    v_mfma_f32_16x16x32_bf16 v[120:123], v[56:59], v[88:91], 0
    v_mfma_f32_16x16x32_bf16 v[124:127], v[66:69], v[88:91], 0
    v_mfma_f32_16x16x32_bf16 v[128:131], v[58:61], v[92:95], 0
    v_mfma_f32_16x16x32_bf16 v[132:135], v[68:71], v[92:95], 0
    v_cvt_pk_bf16_f32 v16, v104, v105
    v_cvt_pk_bf16_f32 v17, v106, v107
    v_cvt_pk_bf16_f32 v18, v108, v109
    v_cvt_pk_bf16_f32 v19, v110, v111
    ds_write_b64 v223, v[16:17]
    ds_write_b64 v224, v[18:19]
    v_cvt_pk_bf16_f32 v20, v112, v113
    v_cvt_pk_bf16_f32 v21, v114, v115
    v_cvt_pk_bf16_f32 v22, v116, v117
    v_cvt_pk_bf16_f32 v23, v118, v119
    v_xor_b32 v100, 16, v223
    v_xor_b32 v101, 16, v224
    ds_write_b64 v100, v[20:21]
    ds_write_b64 v101, v[22:23]
    v_cvt_pk_bf16_f32 v24, v120, v121
    v_cvt_pk_bf16_f32 v25, v122, v123
    v_cvt_pk_bf16_f32 v26, v124, v125
    v_cvt_pk_bf16_f32 v27, v126, v127
    v_xor_b32 v102, 32, v223
    v_xor_b32 v103, 32, v224
    ds_write_b64 v102, v[24:25]
    ds_write_b64 v103, v[26:27]
    v_cvt_pk_bf16_f32 v28, v128, v129
    v_cvt_pk_bf16_f32 v29, v130, v131
    v_cvt_pk_bf16_f32 v30, v132, v133
    v_cvt_pk_bf16_f32 v31, v134, v135
    v_xor_b32 v100, 48, v223
    v_xor_b32 v101, 48, v224
    ds_write_b64 v100, v[28:29]
    ds_write_b64 v101, v[30:31]
    ds_read_b128 v[32:35], v225 offset:0
    v_xor_b32 v49, 64, v225
    ds_read_b128 v[36:39], v49 offset:1024
    v_xor_b32 v50, 128, v225
    ds_read_b128 v[40:43], v50 offset:2048
    v_xor_b32 v51, 192, v225
    ds_read_b128 v[44:47], v51 offset:3072
    s_mov_b32 s46, 0
    s_waitcnt lgkmcnt(3)
    buffer_store_dwordx4 v[32:35], v222, s[20:23], s46 offen sc1
    s_mov_b32 s46, 1048576
    s_waitcnt lgkmcnt(2)
    buffer_store_dwordx4 v[36:39], v222, s[20:23], s46 offen sc1
    s_mov_b32 s46, 2097152
    s_waitcnt lgkmcnt(1)
    buffer_store_dwordx4 v[40:43], v222, s[20:23], s46 offen sc1
    s_mov_b32 s46, 3145728
    s_waitcnt lgkmcnt(0)
    buffer_store_dwordx4 v[44:47], v222, s[20:23], s46 offen sc1
    s_endpgm
K1_LAST:
    s_cmp_eq_u32 s36, 14
    s_cbranch_scc0 K1_NOBAR
    v_mov_b32 v12, 163216
K1_POLL15:
    ds_read_b128 v[248:251], v12
    s_waitcnt lgkmcnt(0)
    v_and_b32 v248, v248, v249
    v_and_b32 v250, v250, v251
    v_and_b32 v248, v248, v250
    s_nop 0
    v_readfirstlane_b32 s46, v248
    s_nop 0
    s_cmp_eq_u32 s46, 1
    s_cbranch_scc0 K1_POLL15
    s_branch K1_NOBAR

.globl k2_kernel
.p2align 8
.type k2_kernel,@function
k2_kernel:
    s_cmp_ge_u32 s2, 256
    s_cbranch_scc1 K2_END
    s_load_dwordx2 s[36:37], s[0:1], 88
    s_load_dwordx2 s[4:5], s[0:1], 16
    s_load_dwordx2 s[8:9], s[0:1], 72
    v_lshrrev_b32 v1, 6, v0
    v_and_b32 v0, 63, v0
    v_readfirstlane_b32 s32, v1
    s_and_b32 s38, s2, 7
    s_lshr_b32 s39, s2, 3
    s_and_b32 s40, s38, 3
    s_and_b32 s41, s39, 3
    s_lshl2_add_u32 s33, s40, s41
    s_lshr_b32 s40, s38, 2
    s_lshr_b32 s41, s39, 2
    s_lshl3_add_u32 s40, s40, s41
    s_add_u32 s40, s40, 12
    s_and_b32 s34, s40, 15
    s_and_b32 s35, s32, 3
    s_lshr_b32 s40, s35, 1
    s_and_b32 s42, s35, 1
    s_sub_u32 s41, 32, s33
    s_cmp_eq_u32 s33, 0
    s_cselect_b32 s41, 16, s41
    s_cselect_b32 s63, 16, s33
    s_cmp_eq_u32 s40, 0
    s_cselect_b32 s41, s33, s41
    s_lshl_b32 s44, s34, 7
    v_lshrrev_b32 v22, 3, v0
    v_and_b32 v23, 7, v0
    s_cmp_lt_u32 s32, 4
    s_cbranch_scc1 K2_COMP
    s_lshl_b32 s49, s42, 2
    v_and_or_b32 v29, v22, 2, s49
    v_xor_b32 v29, v29, v23
    v_lshlrev_b32 v29, 4, v29
    v_lshl_add_u32 v29, v22, 12, v29
    s_lshl_b32 s49, s35, 15
    v_add_u32 v2, s49, v29
    s_lshl_b32 s50, s33, 18
    s_add_u32 s50, s50, s44
    s_add_u32 s50, s50, 4194304
    s_lshl_b32 s51, s63, 18
    s_add_u32 s52, s51, 4196224
    s_sub_u32 s52, s52, s44
    s_lshl_b32 s46, s35, 10
    s_waitcnt lgkmcnt(0)
    s_mov_b32 s16, s36
    s_and_b32 s17, s37, 0xffff
    s_mov_b32 s18, 0xe00000
    s_mov_b32 s19, 0x00020000
    s_add_u32 m0, s46, 0
    s_add_u32 s47, s50, 0
    buffer_load_dwordx4 v2, s[16:19], s47 offen lds
    s_mov_b32 s12, s4
    s_and_b32 s13, s5, 0xffff
    s_mov_b32 s14, 0x200000
    s_mov_b32 s15, 0x00020000
    v_and_b32 v27, 6, v22
    v_xor_b32 v27, v27, v23
    s_add_u32 m0, s46, 4096
    s_add_u32 s47, s50, 2048
    buffer_load_dwordx4 v2, s[16:19], s47 offen lds
    v_lshlrev_b32 v27, 4, v27
    s_lshl_b32 s43, s35, 14
    s_add_u32 s43, s43, s44
    v_lshl_add_u32 v27, v22, 11, v27
    v_add_u32 v3, s43, v27
    s_add_u32 m0, s46, 8192
    s_add_u32 s47, s52, 0
    buffer_load_dwordx4 v2, s[16:19], s47 offen lds
    s_lshl_b32 s43, s41, 17
    s_lshl_b32 s45, s42, 16
    s_add_u32 s43, s43, s45
    v_bfe_u32 v27, v0, 2, 2
    v_lshrrev_b32 v28, 4, v0
    v_lshl_add_u32 v27, v27, 2, v28
    s_add_u32 m0, s46, 12288
    s_add_u32 s47, s52, 2048
    buffer_load_dwordx4 v2, s[16:19], s47 offen lds
    v_and_b32 v28, 3, v0
    v_lshl_add_u32 v27, v27, 2, v28
    v_lshl_add_u32 v4, v27, 4, s43
    v_add_u32 v5, 32768, v4
    s_sub_u32 s53, 16, s34
    s_add_u32 m0, s46, 24576
    s_add_u32 s47, s50, 131072
    buffer_load_dwordx4 v2, s[16:19], s47 offen lds
    s_and_b32 s53, s53, 15
    s_lshl_b32 s53, s53, 7
    s_add_u32 s53, s53, s51
    s_add_u32 s53, s53, s49
    s_add_u32 s53, s53, 4194304
    s_add_u32 m0, s46, 28672
    s_add_u32 s47, s50, 133120
    buffer_load_dwordx4 v2, s[16:19], s47 offen lds
    v_and_b32 v29, 1, v22
    v_bfe_u32 v31, v0, 4, 1
    v_lshlrev_b32 v30, 12, v23
    v_lshl_add_u32 v30, v29, 11, v30
    v_lshl_add_u32 v30, v31, 17, v30
    s_mov_b32 exec_hi, 0
    buffer_load_ushort v8, v30, s[16:19], s53 offen
    s_mov_b32 exec_hi, -1
    s_add_u32 m0, s46, 32768
    s_add_u32 s47, s52, 131072
    buffer_load_dwordx4 v2, s[16:19], s47 offen lds
    v_bfe_u32 v30, v23, 1, 1
    s_lshl_b32 s53, s42, 1
    v_or_b32 v30, s53, v30
    v_lshlrev_b32 v30, 5, v30
    v_lshl_add_u32 v30, v23, 7, v30
    s_add_u32 m0, s46, 36864
    s_add_u32 s47, s52, 133120
    buffer_load_dwordx4 v2, s[16:19], s47 offen lds
    v_lshl_add_u32 v30, v29, 12, v30
    v_mul_u32_u24 v31, 24576, v31
    s_add_u32 s53, s46, 8192
    v_add3_u32 v9, v30, v31, s53
    s_mov_b32 s54, 0
    s_mov_b32 s55, 49152
    s_lshl_b32 s57, s35, 12
    s_add_u32 s57, s57, 8192
    s_and_b32 s54, s54, 15
    s_lshl_b32 s47, s54, 17
    s_lshl_b32 s48, s54, 11
    s_add_u32 s58, s55, s46
    s_add_u32 s59, s55, s57
    s_mov_b32 m0, s58
    s_nop 0
    buffer_load_dwordx4 v3, s[12:15], s47 offen lds
    s_mov_b32 m0, s59
    s_nop 0
    buffer_load_dwordx4 v4, s[16:19], s48 offen lds
    buffer_load_dwordx4 v4, s[16:19], s48 offen offset:1024 lds
    s_add_u32 m0, s58, 4096
    s_add_u32 s47, s47, 65536
    buffer_load_dwordx4 v3, s[12:15], s47 offen lds
    s_add_u32 m0, s59, 2048
    s_add_u32 s54, s54, 1
    buffer_load_dwordx4 v5, s[16:19], s48 offen lds
    buffer_load_dwordx4 v5, s[16:19], s48 offen offset:1024 lds
    s_add_u32 s55, s55, 24576
    s_cmp_eq_u32 s55, 147456
    s_cselect_b32 s55, 0, s55
    s_and_b32 s54, s54, 15
    s_lshl_b32 s47, s54, 17
    s_lshl_b32 s48, s54, 11
    s_add_u32 s58, s55, s46
    s_add_u32 s59, s55, s57
    s_mov_b32 m0, s58
    s_nop 0
    buffer_load_dwordx4 v3, s[12:15], s47 offen lds
    s_mov_b32 m0, s59
    s_nop 0
    buffer_load_dwordx4 v4, s[16:19], s48 offen lds
    buffer_load_dwordx4 v4, s[16:19], s48 offen offset:1024 lds
    s_add_u32 m0, s58, 4096
    s_add_u32 s47, s47, 65536
    buffer_load_dwordx4 v3, s[12:15], s47 offen lds
    s_add_u32 m0, s59, 2048
    s_add_u32 s54, s54, 1
    buffer_load_dwordx4 v5, s[16:19], s48 offen lds
    buffer_load_dwordx4 v5, s[16:19], s48 offen offset:1024 lds
    s_add_u32 s55, s55, 24576
    s_cmp_eq_u32 s55, 147456
    s_cselect_b32 s55, 0, s55
    s_waitcnt vmcnt(12)
    s_mov_b32 exec_hi, 0
    ds_write_b16 v9, v8
    s_mov_b32 exec_hi, -1
    s_waitcnt lgkmcnt(0)
    s_barrier
    s_mov_b32 s56, 2
K2_LD:
    s_and_b32 s54, s54, 15
    s_lshl_b32 s47, s54, 17
    s_lshl_b32 s48, s54, 11
    s_add_u32 s58, s55, s46
    s_add_u32 s59, s55, s57
    s_mov_b32 m0, s58
    s_nop 0
    buffer_load_dwordx4 v3, s[12:15], s47 offen lds
    s_mov_b32 m0, s59
    s_nop 0
    buffer_load_dwordx4 v4, s[16:19], s48 offen lds
    buffer_load_dwordx4 v4, s[16:19], s48 offen offset:1024 lds
    s_waitcnt vmcnt(9)
    s_barrier
    s_add_u32 m0, s58, 4096
    s_add_u32 s47, s47, 65536
    buffer_load_dwordx4 v3, s[12:15], s47 offen lds
    s_add_u32 m0, s59, 2048
    s_add_u32 s54, s54, 1
    buffer_load_dwordx4 v5, s[16:19], s48 offen lds
    buffer_load_dwordx4 v5, s[16:19], s48 offen offset:1024 lds
    s_add_u32 s55, s55, 24576
    s_cmp_eq_u32 s55, 147456
    s_cselect_b32 s55, 0, s55
    s_add_u32 s56, s56, 1
    s_cmp_lt_u32 s56, 16
    s_cbranch_scc1 K2_LD
    s_waitcnt vmcnt(6)
    s_barrier
    s_waitcnt vmcnt(0)
    s_barrier
    s_endpgm
K2_COMP:
    v_and_b32 v20, 15, v0
    v_lshrrev_b32 v21, 4, v0
    s_lshl_b32 s49, s42, 10
    s_add_u32 s49, s49, s41
    v_lshlrev_b32 v24, 5, v20
    v_add_u32 v24, s49, v24
    v_and_b32 v26, 63, v24
    v_lshlrev_b32 v26, 9, v26
    v_lshrrev_b32 v25, 9, v24
    v_lshl_add_u32 v26, v25, 7, v26
    v_bfe_u32 v25, v24, 6, 3
    v_lshl_add_u32 v26, v25, 2, v26
    s_waitcnt lgkmcnt(0)
    s_mov_b32 s16, s36
    s_and_b32 s17, s37, 0xffff
    s_mov_b32 s18, 0xe00000
    s_mov_b32 s19, 0x00020000
    s_mov_b32 s28, s8
    s_and_b32 s29, s9, 0xffff
    s_mov_b32 s30, 0x400000
    s_mov_b32 s31, 0x00020000
    s_mov_b32 s50, 12582912
    buffer_load_dword v16, v26, s[16:19], s50 offen
    buffer_load_dword v17, v26, s[16:19], s50 offen offset:128
    v_lshlrev_b32 v25, 3, v21
    v_cvt_f32_u32 v25, v25
    s_lshl_b32 s50, s40, 31
    s_or_b32 s50, s50, 0x3a000000
    v_add_u32 v27, 0, v24
    v_cvt_f32_u32 v27, v27
    v_mul_f32 v27, s50, v27
    v_mul_f32 v28, v27, v25
    v_fmamk_f32 v29, v27, 0x00000000, v28
    v_add_f32 v30, v29, v27
    v_cos_f32 v128, v29
    v_cos_f32 v129, v30
    v_sin_f32 v130, v29
    v_sin_f32 v131, v30
    v_cvt_pk_bf16_f32 v32, v128, v129
    v_cvt_pk_bf16_f32 v36, v130, v131
    v_fmamk_f32 v29, v27, 0x40000000, v28
    v_add_f32 v30, v29, v27
    v_cos_f32 v128, v29
    v_cos_f32 v129, v30
    v_sin_f32 v130, v29
    v_sin_f32 v131, v30
    v_cvt_pk_bf16_f32 v33, v128, v129
    v_cvt_pk_bf16_f32 v37, v130, v131
    v_fmamk_f32 v29, v27, 0x40800000, v28
    v_add_f32 v30, v29, v27
    v_cos_f32 v128, v29
    v_cos_f32 v129, v30
    v_sin_f32 v130, v29
    v_sin_f32 v131, v30
    v_cvt_pk_bf16_f32 v34, v128, v129
    v_cvt_pk_bf16_f32 v38, v130, v131
    v_fmamk_f32 v29, v27, 0x40c00000, v28
    v_add_f32 v30, v29, v27
    v_cos_f32 v128, v29
    v_cos_f32 v129, v30
    v_sin_f32 v130, v29
    v_sin_f32 v131, v30
    v_cvt_pk_bf16_f32 v35, v128, v129
    v_cvt_pk_bf16_f32 v39, v130, v131
    v_fmamk_f32 v29, v27, 0x42000000, v28
    v_add_f32 v30, v29, v27
    v_cos_f32 v128, v29
    v_cos_f32 v129, v30
    v_sin_f32 v130, v29
    v_sin_f32 v131, v30
    v_cvt_pk_bf16_f32 v40, v128, v129
    v_cvt_pk_bf16_f32 v44, v130, v131
    v_fmamk_f32 v29, v27, 0x42080000, v28
    v_add_f32 v30, v29, v27
    v_cos_f32 v128, v29
    v_cos_f32 v129, v30
    v_sin_f32 v130, v29
    v_sin_f32 v131, v30
    v_cvt_pk_bf16_f32 v41, v128, v129
    v_cvt_pk_bf16_f32 v45, v130, v131
    v_fmamk_f32 v29, v27, 0x42100000, v28
    v_add_f32 v30, v29, v27
    v_cos_f32 v128, v29
    v_cos_f32 v129, v30
    v_sin_f32 v130, v29
    v_sin_f32 v131, v30
    v_cvt_pk_bf16_f32 v42, v128, v129
    v_cvt_pk_bf16_f32 v46, v130, v131
    v_fmamk_f32 v29, v27, 0x42180000, v28
    v_add_f32 v30, v29, v27
    v_cos_f32 v128, v29
    v_cos_f32 v129, v30
    v_sin_f32 v130, v29
    v_sin_f32 v131, v30
    v_cvt_pk_bf16_f32 v43, v128, v129
    v_cvt_pk_bf16_f32 v47, v130, v131
    v_add_u32 v27, 512, v24
    v_cvt_f32_u32 v27, v27
    v_mul_f32 v27, s50, v27
    v_mul_f32 v28, v27, v25
    v_fmamk_f32 v29, v27, 0x00000000, v28
    v_add_f32 v30, v29, v27
    v_cos_f32 v128, v29
    v_cos_f32 v129, v30
    v_sin_f32 v130, v29
    v_sin_f32 v131, v30
    v_cvt_pk_bf16_f32 v48, v128, v129
    v_cvt_pk_bf16_f32 v52, v130, v131
    v_fmamk_f32 v29, v27, 0x40000000, v28
    v_add_f32 v30, v29, v27
    v_cos_f32 v128, v29
    v_cos_f32 v129, v30
    v_sin_f32 v130, v29
    v_sin_f32 v131, v30
    v_cvt_pk_bf16_f32 v49, v128, v129
    v_cvt_pk_bf16_f32 v53, v130, v131
    v_fmamk_f32 v29, v27, 0x40800000, v28
    v_add_f32 v30, v29, v27
    v_cos_f32 v128, v29
    v_cos_f32 v129, v30
    v_sin_f32 v130, v29
    v_sin_f32 v131, v30
    v_cvt_pk_bf16_f32 v50, v128, v129
    v_cvt_pk_bf16_f32 v54, v130, v131
    v_fmamk_f32 v29, v27, 0x40c00000, v28
    v_add_f32 v30, v29, v27
    v_cos_f32 v128, v29
    v_cos_f32 v129, v30
    v_sin_f32 v130, v29
    v_sin_f32 v131, v30
    v_cvt_pk_bf16_f32 v51, v128, v129
    v_cvt_pk_bf16_f32 v55, v130, v131
    v_fmamk_f32 v29, v27, 0x42000000, v28
    v_add_f32 v30, v29, v27
    v_cos_f32 v128, v29
    v_cos_f32 v129, v30
    v_sin_f32 v130, v29
    v_sin_f32 v131, v30
    v_cvt_pk_bf16_f32 v56, v128, v129
    v_cvt_pk_bf16_f32 v60, v130, v131
    v_fmamk_f32 v29, v27, 0x42080000, v28
    v_add_f32 v30, v29, v27
    v_cos_f32 v128, v29
    v_cos_f32 v129, v30
    v_sin_f32 v130, v29
    v_sin_f32 v131, v30
    v_cvt_pk_bf16_f32 v57, v128, v129
    v_cvt_pk_bf16_f32 v61, v130, v131
    v_fmamk_f32 v29, v27, 0x42100000, v28
    v_add_f32 v30, v29, v27
    v_cos_f32 v128, v29
    v_cos_f32 v129, v30
    v_sin_f32 v130, v29
    v_sin_f32 v131, v30
    v_cvt_pk_bf16_f32 v58, v128, v129
    v_cvt_pk_bf16_f32 v62, v130, v131
    v_fmamk_f32 v29, v27, 0x42180000, v28
    v_add_f32 v30, v29, v27
    v_cos_f32 v128, v29
    v_cos_f32 v129, v30
    v_sin_f32 v130, v29
    v_sin_f32 v131, v30
    v_cvt_pk_bf16_f32 v59, v128, v129
    v_cvt_pk_bf16_f32 v63, v130, v131
    v_bfe_u32 v27, v0, 2, 2
    v_and_b32 v28, 3, v0
    v_lshl_add_u32 v29, v21, 3, v27
    v_lshrrev_b32 v30, 1, v27
    v_and_b32 v31, 1, v21
    v_lshl_or_b32 v30, v31, 1, v30
    v_lshlrev_b32 v30, 5, v30
    v_lshl_add_u32 v30, v29, 7, v30
    v_lshl_add_u32 v30, v28, 3, v30
    s_mul_i32 s50, s40, 96
    s_xor_b32 s50, s50, 96
    v_xor_b32 v30, s50, v30
    s_lshl_b32 s50, s40, 13
    v_add_u32 v12, s50, v30
    v_xor_b32 v13, 32, v12
    v_xor_b32 v14, 64, v12
    v_xor_b32 v15, 96, v12
    v_lshl_add_u32 v29, v21, 2, v27
    v_bfe_u32 v30, v29, 1, 2
    v_lshlrev_b32 v30, 5, v30
    v_lshl_add_u32 v30, v29, 7, v30
    v_lshl_add_u32 v30, v28, 3, v30
    v_add_u32 v8, 49152, v30
    v_xor_b32 v9, 32, v8
    v_xor_b32 v10, 64, v8
    v_xor_b32 v11, 96, v8
    s_lshl_b32 s50, s35, 12
    s_add_u32 s51, s50, 57344
    v_lshl_add_u32 v19, v0, 4, s51
    v_sub_u32 v30, 16, v20
    s_cmp_eq_u32 s40, 1
    s_cselect_b64 vcc, -1, 0
    v_cndmask_b32 v29, v20, v30, vcc
    v_lshlrev_b32 v30, 2, v21
    v_sub_u32 v29, v29, v30
    v_and_b32 v30, 1, v29
    v_lshlrev_b32 v30, 4, v30
    v_mov_b32 v228, 0x3f80
    v_lshlrev_b32 v30, v30, v228
    v_lshrrev_b32 v29, 1, v29
    v_cmp_eq_u32 vcc, 0, v29
    s_nop 1
    v_cndmask_b32 v228, 0, v30, vcc
    v_cmp_eq_u32 vcc, 1, v29
    s_nop 1
    v_cndmask_b32 v229, 0, v30, vcc
    v_cmp_eq_u32 vcc, 8, v29
    s_nop 1
    v_cndmask_b32 v230, 0, v30, vcc
    v_cmp_eq_u32 vcc, 9, v29
    s_nop 1
    v_cndmask_b32 v231, 0, v30, vcc
    s_add_u32 s50, s50, 147456
    v_lshrrev_b32 v29, 1, v21
    v_and_b32 v30, 7, v20
    v_xor_b32 v29, v29, v30
    v_lshlrev_b32 v29, 4, v29
    v_lshl_add_u32 v29, v31, 3, v29
    v_lshl_add_u32 v29, v20, 7, v29
    v_add_u32 v4, s50, v29
    v_xor_b32 v233, 32, v4
    v_xor_b32 v234, 64, v4
    v_xor_b32 v235, 96, v4
    v_xor_b32 v29, v22, v23
    v_lshlrev_b32 v29, 4, v29
    v_lshl_add_u32 v29, v22, 7, v29
    v_add_u32 v5, s50, v29
    v_lshlrev_b32 v29, 5, v22
    v_add_u32 v29, s49, v29
    v_lshlrev_b32 v29, 11, v29
    v_lshl_add_u32 v29, v23, 4, v29
    v_add_u32 v18, s44, v29
    v_mov_b32 v64, 0
    v_mov_b32 v65, 0
    v_mov_b32 v66, 0
    v_mov_b32 v67, 0
    v_mov_b32 v68, 0
    v_mov_b32 v69, 0
    v_mov_b32 v70, 0
    v_mov_b32 v71, 0
    v_mov_b32 v72, 0
    v_mov_b32 v73, 0
    v_mov_b32 v74, 0
    v_mov_b32 v75, 0
    v_mov_b32 v76, 0
    v_mov_b32 v77, 0
    v_mov_b32 v78, 0
    v_mov_b32 v79, 0
    v_mov_b32 v80, 0
    v_mov_b32 v81, 0
    v_mov_b32 v82, 0
    v_mov_b32 v83, 0
    v_mov_b32 v84, 0
    v_mov_b32 v85, 0
    v_mov_b32 v86, 0
    v_mov_b32 v87, 0
    v_mov_b32 v88, 0
    v_mov_b32 v89, 0
    v_mov_b32 v90, 0
    v_mov_b32 v91, 0
    v_mov_b32 v92, 0
    v_mov_b32 v93, 0
    v_mov_b32 v94, 0
    v_mov_b32 v95, 0
    s_mov_b32 s52, 2
    s_mov_b32 s53, 0
    s_mov_b32 s55, 24576
    s_mov_b32 s56, 4294844416
    s_barrier
    ds_read_b64_tr_b16 v[128:129], v12 offset:0
    ds_read_b64_tr_b16 v[130:131], v12 offset:512
    ds_read_b64_tr_b16 v[132:133], v13 offset:0
    ds_read_b64_tr_b16 v[134:135], v13 offset:512
    ds_read_b64_tr_b16 v[136:137], v14 offset:0
    ds_read_b64_tr_b16 v[138:139], v14 offset:512
    ds_read_b64_tr_b16 v[140:141], v15 offset:0
    ds_read_b64_tr_b16 v[142:143], v15 offset:512
    ds_read_b64_tr_b16 v[144:145], v12 offset:4096
    ds_read_b64_tr_b16 v[146:147], v12 offset:4608
    ds_read_b64_tr_b16 v[148:149], v13 offset:4096
    ds_read_b64_tr_b16 v[150:151], v13 offset:4608
    s_waitcnt lgkmcnt(10)
    v_mfma_f32_16x16x32_bf16 v[96:99], v[128:131], v[32:35], 0
    ds_read_b64_tr_b16 v[152:153], v14 offset:4096
    v_mfma_f32_16x16x32_bf16 v[112:115], v[128:131], v[48:51], 0
    ds_read_b64_tr_b16 v[154:155], v14 offset:4608
    s_waitcnt lgkmcnt(10)
    v_mfma_f32_16x16x32_bf16 v[100:103], v[132:135], v[32:35], 0
    ds_read_b64_tr_b16 v[156:157], v15 offset:4096
    v_mfma_f32_16x16x32_bf16 v[116:119], v[132:135], v[48:51], 0
    ds_read_b64_tr_b16 v[158:159], v15 offset:4608
    s_waitcnt lgkmcnt(10)
    v_mfma_f32_16x16x32_bf16 v[104:107], v[136:139], v[32:35], 0
    ds_read_b64_tr_b16 v[160:161], v12 offset:24576
    v_mfma_f32_16x16x32_bf16 v[120:123], v[136:139], v[48:51], 0
    ds_read_b64_tr_b16 v[162:163], v12 offset:25088
    s_waitcnt lgkmcnt(10)
    v_mfma_f32_16x16x32_bf16 v[108:111], v[140:143], v[32:35], 0
    ds_read_b64_tr_b16 v[164:165], v13 offset:24576
    v_mfma_f32_16x16x32_bf16 v[124:127], v[140:143], v[48:51], 0
    ds_read_b64_tr_b16 v[166:167], v13 offset:25088
    s_waitcnt lgkmcnt(10)
    v_mfma_f32_16x16x32_bf16 v[96:99], v[144:147], v[36:39], v[96:99]
    ds_read_b64_tr_b16 v[168:169], v14 offset:24576
    v_mfma_f32_16x16x32_bf16 v[112:115], v[144:147], v[52:55], v[112:115]
    ds_read_b64_tr_b16 v[170:171], v14 offset:25088
    s_waitcnt lgkmcnt(10)
    v_mfma_f32_16x16x32_bf16 v[100:103], v[148:151], v[36:39], v[100:103]
    ds_read_b64_tr_b16 v[172:173], v15 offset:24576
    v_mfma_f32_16x16x32_bf16 v[116:119], v[148:151], v[52:55], v[116:119]
    ds_read_b64_tr_b16 v[174:175], v15 offset:25088
    s_waitcnt lgkmcnt(10)
    v_mfma_f32_16x16x32_bf16 v[104:107], v[152:155], v[36:39], v[104:107]
    ds_read_b64_tr_b16 v[176:177], v12 offset:28672
    v_mfma_f32_16x16x32_bf16 v[120:123], v[152:155], v[52:55], v[120:123]
    ds_read_b64_tr_b16 v[178:179], v12 offset:29184
    s_waitcnt lgkmcnt(10)
    v_mfma_f32_16x16x32_bf16 v[108:111], v[156:159], v[36:39], v[108:111]
    ds_read_b64_tr_b16 v[180:181], v13 offset:28672
    v_mfma_f32_16x16x32_bf16 v[124:127], v[156:159], v[52:55], v[124:127]
    ds_read_b64_tr_b16 v[182:183], v13 offset:29184
    s_waitcnt lgkmcnt(10)
    v_mfma_f32_16x16x32_bf16 v[96:99], v[160:163], v[40:43], v[96:99]
    ds_read_b64_tr_b16 v[184:185], v14 offset:28672
    v_mfma_f32_16x16x32_bf16 v[112:115], v[160:163], v[56:59], v[112:115]
    ds_read_b64_tr_b16 v[186:187], v14 offset:29184
    s_waitcnt lgkmcnt(10)
    v_mfma_f32_16x16x32_bf16 v[100:103], v[164:167], v[40:43], v[100:103]
    ds_read_b64_tr_b16 v[188:189], v15 offset:28672
    v_mfma_f32_16x16x32_bf16 v[116:119], v[164:167], v[56:59], v[116:119]
    ds_read_b64_tr_b16 v[190:191], v15 offset:29184
    s_waitcnt lgkmcnt(10)
    v_mfma_f32_16x16x32_bf16 v[104:107], v[168:171], v[40:43], v[104:107]
    v_mfma_f32_16x16x32_bf16 v[120:123], v[168:171], v[56:59], v[120:123]
    s_waitcnt lgkmcnt(8)
    v_mfma_f32_16x16x32_bf16 v[108:111], v[172:175], v[40:43], v[108:111]
    v_mfma_f32_16x16x32_bf16 v[124:127], v[172:175], v[56:59], v[124:127]
    s_waitcnt lgkmcnt(6)
    v_mfma_f32_16x16x32_bf16 v[96:99], v[176:179], v[44:47], v[96:99]
    v_mfma_f32_16x16x32_bf16 v[112:115], v[176:179], v[60:63], v[112:115]
    s_waitcnt lgkmcnt(4)
    v_mfma_f32_16x16x32_bf16 v[100:103], v[180:183], v[44:47], v[100:103]
    v_mfma_f32_16x16x32_bf16 v[116:119], v[180:183], v[60:63], v[116:119]
    s_waitcnt lgkmcnt(2)
    v_mfma_f32_16x16x32_bf16 v[104:107], v[184:187], v[44:47], v[104:107]
    v_mfma_f32_16x16x32_bf16 v[120:123], v[184:187], v[60:63], v[120:123]
    s_waitcnt lgkmcnt(0)
    v_mfma_f32_16x16x32_bf16 v[108:111], v[188:191], v[44:47], v[108:111]
    v_mfma_f32_16x16x32_bf16 v[124:127], v[188:191], v[60:63], v[124:127]
    s_waitcnt vmcnt(0)
    v_sub_f32 v20, 1.0, v16
    v_sub_f32 v21, 1.0, v17
    v_mul_f32 v96, v96, v20
    v_mul_f32 v97, v97, v20
    v_mul_f32 v98, v98, v20
    v_mul_f32 v99, v99, v20
    v_cvt_pk_bf16_f32 v208, v96, v97
    v_cvt_pk_bf16_f32 v209, v98, v99
    v_mul_f32 v100, v100, v20
    v_mul_f32 v101, v101, v20
    v_mul_f32 v102, v102, v20
    v_mul_f32 v103, v103, v20
    v_cvt_pk_bf16_f32 v210, v100, v101
    v_cvt_pk_bf16_f32 v211, v102, v103
    v_mul_f32 v104, v104, v20
    v_mul_f32 v105, v105, v20
    v_mul_f32 v106, v106, v20
    v_mul_f32 v107, v107, v20
    v_cvt_pk_bf16_f32 v212, v104, v105
    v_cvt_pk_bf16_f32 v213, v106, v107
    v_mul_f32 v108, v108, v20
    v_mul_f32 v109, v109, v20
    v_mul_f32 v110, v110, v20
    v_mul_f32 v111, v111, v20
    v_cvt_pk_bf16_f32 v214, v108, v109
    v_cvt_pk_bf16_f32 v215, v110, v111
    v_mov_b32 v216, v208
    v_mov_b32 v217, v209
    v_mul_f32 v112, v112, v21
    v_mul_f32 v113, v113, v21
    v_mul_f32 v114, v114, v21
    v_mul_f32 v115, v115, v21
    v_cvt_pk_bf16_f32 v218, v112, v113
    v_cvt_pk_bf16_f32 v219, v114, v115
    v_mul_f32 v116, v116, v21
    v_mul_f32 v117, v117, v21
    v_mul_f32 v118, v118, v21
    v_mul_f32 v119, v119, v21
    v_cvt_pk_bf16_f32 v220, v116, v117
    v_cvt_pk_bf16_f32 v221, v118, v119
    v_mul_f32 v120, v120, v21
    v_mul_f32 v121, v121, v21
    v_mul_f32 v122, v122, v21
    v_mul_f32 v123, v123, v21
    v_cvt_pk_bf16_f32 v222, v120, v121
    v_cvt_pk_bf16_f32 v223, v122, v123
    v_mul_f32 v124, v124, v21
    v_mul_f32 v125, v125, v21
    v_mul_f32 v126, v126, v21
    v_mul_f32 v127, v127, v21
    v_cvt_pk_bf16_f32 v224, v124, v125
    v_cvt_pk_bf16_f32 v225, v126, v127
    v_mov_b32 v226, v218
    v_mov_b32 v227, v219
    v_mfma_f32_16x16x32_bf16 v[96:99], v[228:231], v[214:217], 0
    v_mfma_f32_16x16x32_bf16 v[100:103], v[228:231], v[212:215], 0
    v_mfma_f32_16x16x32_bf16 v[104:107], v[228:231], v[210:213], 0
    v_mfma_f32_16x16x32_bf16 v[108:111], v[228:231], v[208:211], 0
    v_mfma_f32_16x16x32_bf16 v[112:115], v[228:231], v[224:227], 0
    v_mfma_f32_16x16x32_bf16 v[116:119], v[228:231], v[222:225], 0
    v_mfma_f32_16x16x32_bf16 v[120:123], v[228:231], v[220:223], 0
    v_mfma_f32_16x16x32_bf16 v[124:127], v[228:231], v[218:221], 0
    s_barrier
    ds_read_b128 v[192:195], v19 offset:0
    ds_read_b128 v[200:203], v19 offset:2048
    ds_read_b64_tr_b16 v[128:129], v8 offset:0
    ds_read_b64_tr_b16 v[130:131], v8 offset:2048
    ds_read_b64_tr_b16 v[132:133], v9 offset:0
    ds_read_b64_tr_b16 v[134:135], v9 offset:2048
    ds_read_b64_tr_b16 v[136:137], v10 offset:0
    ds_read_b64_tr_b16 v[138:139], v10 offset:2048
    ds_read_b64_tr_b16 v[140:141], v11 offset:0
    ds_read_b64_tr_b16 v[142:143], v11 offset:2048
    ds_read_b128 v[196:199], v19 offset:1024
    ds_read_b128 v[204:207], v19 offset:3072
    ds_read_b64_tr_b16 v[144:145], v8 offset:4096
    ds_read_b64_tr_b16 v[146:147], v8 offset:6144
    ds_read_b64_tr_b16 v[148:149], v9 offset:4096
    ds_read_b64_tr_b16 v[150:151], v9 offset:6144
    ds_read_b64_tr_b16 v[152:153], v10 offset:4096
    ds_read_b64_tr_b16 v[154:155], v10 offset:6144
    ds_read_b64_tr_b16 v[156:157], v11 offset:4096
    ds_read_b64_tr_b16 v[158:159], v11 offset:6144
    s_add_u32 s52, s52, 1
    s_cmp_eq_u32 s52, 6
    s_cselect_b32 s54, s56, s55
    s_cselect_b32 s52, 0, s52
    v_add_u32 v8, s54, v8
    v_add_u32 v9, s54, v9
    v_add_u32 v10, s54, v10
    v_add_u32 v11, s54, v11
    v_add_u32 v19, s54, v19
K2_LOOP:
    s_waitcnt lgkmcnt(0)
    s_barrier
    v_mfma_f32_16x16x32_bf16 v[64:67], v[128:131], v[192:195], v[64:67]
    ds_read_b128 v[32:35], v19 offset:0
    ds_read_b128 v[40:43], v19 offset:2048
    v_mfma_f32_16x16x32_bf16 v[80:83], v[128:131], v[200:203], v[80:83]
    ds_read_b64_tr_b16 v[160:161], v8 offset:0
    ds_read_b64_tr_b16 v[162:163], v8 offset:2048
    v_mfma_f32_16x16x32_bf16 v[68:71], v[132:135], v[192:195], v[68:71]
    ds_read_b64_tr_b16 v[164:165], v9 offset:0
    ds_read_b64_tr_b16 v[166:167], v9 offset:2048
    v_mfma_f32_16x16x32_bf16 v[84:87], v[132:135], v[200:203], v[84:87]
    ds_read_b64_tr_b16 v[168:169], v10 offset:0
    ds_read_b64_tr_b16 v[170:171], v10 offset:2048
    v_mfma_f32_16x16x32_bf16 v[72:75], v[136:139], v[192:195], v[72:75]
    ds_read_b64_tr_b16 v[172:173], v11 offset:0
    ds_read_b64_tr_b16 v[174:175], v11 offset:2048
    v_mfma_f32_16x16x32_bf16 v[88:91], v[136:139], v[200:203], v[88:91]
    ds_read_b128 v[36:39], v19 offset:1024
    ds_read_b128 v[44:47], v19 offset:3072
    v_mfma_f32_16x16x32_bf16 v[76:79], v[140:143], v[192:195], v[76:79]
    ds_read_b64_tr_b16 v[176:177], v8 offset:4096
    ds_read_b64_tr_b16 v[178:179], v8 offset:6144
    v_mfma_f32_16x16x32_bf16 v[92:95], v[140:143], v[200:203], v[92:95]
    ds_read_b64_tr_b16 v[180:181], v9 offset:4096
    ds_read_b64_tr_b16 v[182:183], v9 offset:6144
    v_mfma_f32_16x16x32_bf16 v[64:67], v[144:147], v[196:199], v[64:67]
    ds_read_b64_tr_b16 v[184:185], v10 offset:4096
    ds_read_b64_tr_b16 v[186:187], v10 offset:6144
    v_mfma_f32_16x16x32_bf16 v[80:83], v[144:147], v[204:207], v[80:83]
    ds_read_b64_tr_b16 v[188:189], v11 offset:4096
    ds_read_b64_tr_b16 v[190:191], v11 offset:6144
    v_mfma_f32_16x16x32_bf16 v[68:71], v[148:151], v[196:199], v[68:71]
    s_add_u32 s52, s52, 1
    s_cmp_eq_u32 s52, 6
    s_cselect_b32 s54, s56, s55
    s_cselect_b32 s52, 0, s52
    v_mfma_f32_16x16x32_bf16 v[84:87], v[148:151], v[204:207], v[84:87]
    v_add_u32 v8, s54, v8
    v_mfma_f32_16x16x32_bf16 v[72:75], v[152:155], v[196:199], v[72:75]
    v_add_u32 v9, s54, v9
    v_mfma_f32_16x16x32_bf16 v[88:91], v[152:155], v[204:207], v[88:91]
    v_add_u32 v10, s54, v10
    v_mfma_f32_16x16x32_bf16 v[76:79], v[156:159], v[196:199], v[76:79]
    v_add_u32 v11, s54, v11
    v_mfma_f32_16x16x32_bf16 v[92:95], v[156:159], v[204:207], v[92:95]
    v_add_u32 v19, s54, v19
    s_add_u32 s53, s53, 1
    s_cmp_eq_u32 s53, 8
    s_cbranch_scc1 K2_LAST
    s_waitcnt lgkmcnt(0)
    s_barrier
    v_mfma_f32_16x16x32_bf16 v[64:67], v[160:163], v[32:35], v[64:67]
    ds_read_b128 v[192:195], v19 offset:0
    ds_read_b128 v[200:203], v19 offset:2048
    v_mfma_f32_16x16x32_bf16 v[80:83], v[160:163], v[40:43], v[80:83]
    ds_read_b64_tr_b16 v[128:129], v8 offset:0
    ds_read_b64_tr_b16 v[130:131], v8 offset:2048
    v_mfma_f32_16x16x32_bf16 v[68:71], v[164:167], v[32:35], v[68:71]
    ds_read_b64_tr_b16 v[132:133], v9 offset:0
    ds_read_b64_tr_b16 v[134:135], v9 offset:2048
    v_mfma_f32_16x16x32_bf16 v[84:87], v[164:167], v[40:43], v[84:87]
    ds_read_b64_tr_b16 v[136:137], v10 offset:0
    ds_read_b64_tr_b16 v[138:139], v10 offset:2048
    v_mfma_f32_16x16x32_bf16 v[72:75], v[168:171], v[32:35], v[72:75]
    ds_read_b64_tr_b16 v[140:141], v11 offset:0
    ds_read_b64_tr_b16 v[142:143], v11 offset:2048
    v_mfma_f32_16x16x32_bf16 v[88:91], v[168:171], v[40:43], v[88:91]
    ds_read_b128 v[196:199], v19 offset:1024
    ds_read_b128 v[204:207], v19 offset:3072
    v_mfma_f32_16x16x32_bf16 v[76:79], v[172:175], v[32:35], v[76:79]
    ds_read_b64_tr_b16 v[144:145], v8 offset:4096
    ds_read_b64_tr_b16 v[146:147], v8 offset:6144
    v_mfma_f32_16x16x32_bf16 v[92:95], v[172:175], v[40:43], v[92:95]
    ds_read_b64_tr_b16 v[148:149], v9 offset:4096
    ds_read_b64_tr_b16 v[150:151], v9 offset:6144
    v_mfma_f32_16x16x32_bf16 v[64:67], v[176:179], v[36:39], v[64:67]
    ds_read_b64_tr_b16 v[152:153], v10 offset:4096
    ds_read_b64_tr_b16 v[154:155], v10 offset:6144
    v_mfma_f32_16x16x32_bf16 v[80:83], v[176:179], v[44:47], v[80:83]
    ds_read_b64_tr_b16 v[156:157], v11 offset:4096
    ds_read_b64_tr_b16 v[158:159], v11 offset:6144
    v_mfma_f32_16x16x32_bf16 v[68:71], v[180:183], v[36:39], v[68:71]
    s_add_u32 s52, s52, 1
    s_cmp_eq_u32 s52, 6
    s_cselect_b32 s54, s56, s55
    s_cselect_b32 s52, 0, s52
    v_mfma_f32_16x16x32_bf16 v[84:87], v[180:183], v[44:47], v[84:87]
    v_add_u32 v8, s54, v8
    v_mfma_f32_16x16x32_bf16 v[72:75], v[184:187], v[36:39], v[72:75]
    v_add_u32 v9, s54, v9
    v_mfma_f32_16x16x32_bf16 v[88:91], v[184:187], v[44:47], v[88:91]
    v_add_u32 v10, s54, v10
    v_mfma_f32_16x16x32_bf16 v[76:79], v[188:191], v[36:39], v[76:79]
    v_add_u32 v11, s54, v11
    v_mfma_f32_16x16x32_bf16 v[92:95], v[188:191], v[44:47], v[92:95]
    v_add_u32 v19, s54, v19
    s_branch K2_LOOP
K2_LAST:
    s_waitcnt lgkmcnt(0)
    v_mfma_f32_16x16x32_bf16 v[64:67], v[160:163], v[32:35], v[64:67]
    v_mfma_f32_16x16x32_bf16 v[80:83], v[160:163], v[40:43], v[80:83]
    v_mfma_f32_16x16x32_bf16 v[68:71], v[164:167], v[32:35], v[68:71]
    v_mfma_f32_16x16x32_bf16 v[84:87], v[164:167], v[40:43], v[84:87]
    v_mfma_f32_16x16x32_bf16 v[72:75], v[168:171], v[32:35], v[72:75]
    v_mfma_f32_16x16x32_bf16 v[88:91], v[168:171], v[40:43], v[88:91]
    v_mfma_f32_16x16x32_bf16 v[76:79], v[172:175], v[32:35], v[76:79]
    v_mfma_f32_16x16x32_bf16 v[92:95], v[172:175], v[40:43], v[92:95]
    v_mfma_f32_16x16x32_bf16 v[64:67], v[176:179], v[36:39], v[64:67]
    v_mfma_f32_16x16x32_bf16 v[80:83], v[176:179], v[44:47], v[80:83]
    v_mfma_f32_16x16x32_bf16 v[68:71], v[180:183], v[36:39], v[68:71]
    v_mfma_f32_16x16x32_bf16 v[84:87], v[180:183], v[44:47], v[84:87]
    v_mfma_f32_16x16x32_bf16 v[72:75], v[184:187], v[36:39], v[72:75]
    v_mfma_f32_16x16x32_bf16 v[88:91], v[184:187], v[44:47], v[88:91]
    v_mfma_f32_16x16x32_bf16 v[76:79], v[188:191], v[36:39], v[76:79]
    v_mfma_f32_16x16x32_bf16 v[92:95], v[188:191], v[44:47], v[92:95]
    s_nop 0
    v_fmac_f32 v96, v64, v16
    v_fmac_f32 v97, v65, v16
    v_fmac_f32 v98, v66, v16
    v_fmac_f32 v99, v67, v16
    v_cvt_pk_bf16_f32 v128, v96, v97
    v_cvt_pk_bf16_f32 v129, v98, v99
    ds_write_b64 v4, v[128:129] offset:0
    v_fmac_f32 v100, v68, v16
    v_fmac_f32 v101, v69, v16
    v_fmac_f32 v102, v70, v16
    v_fmac_f32 v103, v71, v16
    v_cvt_pk_bf16_f32 v130, v100, v101
    v_cvt_pk_bf16_f32 v131, v102, v103
    ds_write_b64 v233, v[130:131] offset:0
    v_fmac_f32 v104, v72, v16
    v_fmac_f32 v105, v73, v16
    v_fmac_f32 v106, v74, v16
    v_fmac_f32 v107, v75, v16
    v_cvt_pk_bf16_f32 v132, v104, v105
    v_cvt_pk_bf16_f32 v133, v106, v107
    ds_write_b64 v234, v[132:133] offset:0
    v_fmac_f32 v108, v76, v16
    v_fmac_f32 v109, v77, v16
    v_fmac_f32 v110, v78, v16
    v_fmac_f32 v111, v79, v16
    v_cvt_pk_bf16_f32 v134, v108, v109
    v_cvt_pk_bf16_f32 v135, v110, v111
    ds_write_b64 v235, v[134:135] offset:0
    ds_read_b128 v[144:147], v5 offset:0
    ds_read_b128 v[148:151], v5 offset:1024
    v_fmac_f32 v112, v80, v17
    v_fmac_f32 v113, v81, v17
    v_fmac_f32 v114, v82, v17
    v_fmac_f32 v115, v83, v17
    v_cvt_pk_bf16_f32 v136, v112, v113
    v_cvt_pk_bf16_f32 v137, v114, v115
    ds_write_b64 v4, v[136:137] offset:2048
    v_fmac_f32 v116, v84, v17
    v_fmac_f32 v117, v85, v17
    v_fmac_f32 v118, v86, v17
    v_fmac_f32 v119, v87, v17
    v_cvt_pk_bf16_f32 v138, v116, v117
    v_cvt_pk_bf16_f32 v139, v118, v119
    ds_write_b64 v233, v[138:139] offset:2048
    v_fmac_f32 v120, v88, v17
    v_fmac_f32 v121, v89, v17
    v_fmac_f32 v122, v90, v17
    v_fmac_f32 v123, v91, v17
    v_cvt_pk_bf16_f32 v140, v120, v121
    v_cvt_pk_bf16_f32 v141, v122, v123
    ds_write_b64 v234, v[140:141] offset:2048
    v_fmac_f32 v124, v92, v17
    v_fmac_f32 v125, v93, v17
    v_fmac_f32 v126, v94, v17
    v_fmac_f32 v127, v95, v17
    v_cvt_pk_bf16_f32 v142, v124, v125
    v_cvt_pk_bf16_f32 v143, v126, v127
    ds_write_b64 v235, v[142:143] offset:2048
    ds_read_b128 v[152:155], v5 offset:2048
    ds_read_b128 v[156:159], v5 offset:3072
    s_mov_b32 s47, 0
    s_waitcnt lgkmcnt(7)
    buffer_store_dwordx4 v[144:147], v18, s[28:31], s47 offen sc1
    s_mov_b32 s47, 524288
    s_waitcnt lgkmcnt(6)
    buffer_store_dwordx4 v[148:151], v18, s[28:31], s47 offen sc1
    s_mov_b32 s47, 1048576
    s_waitcnt lgkmcnt(1)
    buffer_store_dwordx4 v[152:155], v18, s[28:31], s47 offen sc1
    s_mov_b32 s47, 1572864
    s_waitcnt lgkmcnt(0)
    buffer_store_dwordx4 v[156:159], v18, s[28:31], s47 offen sc1
K2_END:
    s_endpgm
CODE_END:

.section .rodata,"a"
.p2align 6
.amdhsa_kernel k1_kernel
  .amdhsa_next_free_vgpr 256
  .amdhsa_next_free_sgpr 96
  .amdhsa_accum_offset 256
  .amdhsa_group_segment_fixed_size 0
  .amdhsa_kernarg_size 96
  .amdhsa_user_sgpr_count 2
  .amdhsa_user_sgpr_kernarg_segment_ptr 1
  .amdhsa_system_sgpr_workgroup_id_x 1
.end_amdhsa_kernel
.p2align 6
.amdhsa_kernel k2_kernel
  .amdhsa_next_free_vgpr 256
  .amdhsa_next_free_sgpr 96
  .amdhsa_accum_offset 256
  .amdhsa_group_segment_fixed_size 0
  .amdhsa_kernarg_size 96
  .amdhsa_user_sgpr_count 2
  .amdhsa_user_sgpr_kernarg_segment_ptr 1
  .amdhsa_system_sgpr_workgroup_id_x 1
.end_amdhsa_kernel
```
